```python
import torch

def _softmax(x, axis=-1):
    return torch.softmax(x, dim=axis)
def _gelu(x):
    return torch.nn.functional.gelu(x, approximate="tanh")
def _silu(x):
    return torch.nn.functional.silu(x)
def _sigmoid(x):
    return torch.sigmoid(x)
def _layernorm(x, axis=-1, eps=1e-5):
    m = x.mean(dim=axis, keepdim=True)
    v = x.var(dim=axis, keepdim=True, unbiased=False)
    return (x - m) / torch.sqrt(v + eps)
def _scatter_add(tgt, idx, src, axis=0):
    return tgt.clone().index_add_(axis, idx, src)
def _segment_sum(src, seg, n):
    out = torch.zeros((n,) + src.shape[1:], dtype=src.dtype)
    return out.index_add_(0, seg, src)
def _pad(x, pw):
    flat = tuple(v for pair in reversed(pw) for v in pair)
    return torch.nn.functional.pad(x, flat)

kernel_name = 'gated_mix__sliding_block_cached__swiglu_ffn__decode'

def setup_inputs():

    _w = (lambda a: (lambda t: t.to(torch.bfloat16) if t.is_floating_point() else t)(torch.as_tensor(a)))
    def _A_setup():
        B, Sq, D = 2, 1, 512
        Hq, Hkv, Sk, Dh = 32, 8, 16384, 128
        assert Hq % Hkv == 0, (Hq, Hkv)
        return {
            "x": _w((lambda *s: torch.randn(*s, dtype=torch.bfloat16) * 0.05)(B, Sq, D)),
            "k_cache": _w((lambda *s: torch.randn(*s, dtype=torch.bfloat16) * 6.4)(B, Hkv, Sk, Dh)),
            "v_cache": _w((lambda *s: torch.randn(*s, dtype=torch.bfloat16) * 0.4)(B, Hkv, Sk, Dh)),
            "wq": _w((lambda *s: torch.randn(*s, dtype=torch.bfloat16) * 6.4)(D, Hq * Dh) * (D ** -0.5)),
            "wo": _w((lambda *s: torch.randn(*s, dtype=torch.bfloat16) * 0.4)(Hq * Dh, D) * ((Hq * Dh) ** -0.5)),
        }
    _A_in = _A_setup()

    def _B_setup():
        B, S, D, F = 2, 1, 512, 1792
        return {
            "x": _w((lambda *s: torch.randn(*s, dtype=torch.bfloat16) * 0.05)(B, S, D)),
            "w_gate": _w((lambda *s: torch.randn(*s, dtype=torch.bfloat16) * 0.05)(D, F)),
            "w_up": _w((lambda *s: torch.randn(*s, dtype=torch.bfloat16) * 0.05)(D, F)),
            "w_down": _w((lambda *s: torch.randn(*s, dtype=torch.bfloat16) * 0.05)(F, D)),
        }
    _B_in = _B_setup()

    return {
        "A_x": _A_in["x"],
        "A_k_cache": _A_in["k_cache"],
        "A_v_cache": _A_in["v_cache"],
        "A_wq": _A_in["wq"],
        "A_wo": _A_in["wo"],
        "B_x": _B_in["x"],
        "B_w_gate": _B_in["w_gate"],
        "B_w_up": _B_in["w_up"],
        "B_w_down": _B_in["w_down"],
        "gate_w": _w((lambda *s: torch.randn(*s, dtype=torch.bfloat16) * 0.05)(512) * 16.0),
    }

def reference(A_x, A_k_cache, A_v_cache, A_wq, A_wo, B_x, B_w_gate, B_w_up, B_w_down, gate_w):
    def _A_ref(x, k_cache, v_cache, wq, wo):
        B, Sq, D = x.shape
        Hq, Dh = 32, 128
        Hkv, Sk = k_cache.shape[1], k_cache.shape[2]
        W = min(4096, max(256, Sk // 4))
        rep = Hq // Hkv
        q = (lambda x, *d: x.permute(*d))((x @ wq).reshape(B, Sq, Hq, Dh), 0, 2, 1, 3)
        k = (lambda x, n, axis: torch.repeat_interleave(x, n, dim=axis))(k_cache[:, :, Sk - W:, :], rep, axis=1)
        v = (lambda x, n, axis: torch.repeat_interleave(x, n, dim=axis))(v_cache[:, :, Sk - W:, :], rep, axis=1)
        scores = torch.einsum("bhqd,bhkd->bhqk", q, k) * (Dh ** -0.5)
        p = _softmax(scores, axis=-1)
        o = torch.einsum("bhqk,bhkd->bhqd", p, v)
        return (lambda x, *d: x.permute(*d))(o, 0, 2, 1, 3).reshape(B, Sq, Hq * Dh) @ wo

    def _B_ref(x, w_gate, w_up, w_down):
        g = _silu(x @ w_gate)
        u = x @ w_up
        return (g * u) @ w_down

    x = A_x
    g = _sigmoid((x * gate_w).sum(-1, keepdims=True))
    a = _A_ref(x, A_k_cache, A_v_cache, A_wq, A_wo)
    b = _B_ref(x, B_w_gate, B_w_up, B_w_down)
    return g * a + (1 - g) * b
```

```asm
; @launch grid=(256,1,1) block=(704,1,1) lds=159488
.amdgcn_target "amdgcn-amd-amdhsa--gfx950"
.text
.globl gated_mix__sliding_block_cached__swiglu_ffn__decode_kernel
.p2align 8
.type gated_mix__sliding_block_cached__swiglu_ffn__decode_kernel,@function
gated_mix__sliding_block_cached__swiglu_ffn__decode_kernel:
    s_load_dwordx16 s[8:23], s[0:1], 0
    s_load_dwordx8 s[24:31], s[0:1], 64
    s_load_dwordx2 s[32:33], s[0:1], 96
    s_getpc_b64 s[4:5]
L_pc:
    s_cmp_ge_u32 s2, 256
    s_cbranch_scc1 L_end
    s_lshr_b32 s36, s2, 3
    s_and_b32 s3, s36, 7
    s_mulk_i32 s3, 2816
    v_lshl_add_u32 v1, v0, 2, s3
    v_min_u32 v1, L_end-L_pc, v1
    global_load_dword v167, v1, s[4:5]
    v_lshrrev_b32 v1, 6, v0
    v_and_b32 v0, 63, v0
    v_readfirstlane_b32 s37, v1
    s_and_b32 s35, s2, 7
    v_lshrrev_b32 v2, 4, v0
    v_and_b32 v3, 15, v0
    s_cmp_lt_u32 s37, 3
    s_cbranch_scc1 L_aux
    v_lshlrev_b32 v4, 2, v0
    v_mov_b32 v5, -1
    v_add_u32 v4, 158720, v4
    ds_write_b32 v4, v5
    ds_write_b32 v4, v5 offset:272
    s_barrier
    s_waitcnt lgkmcnt(0)
    s_barrier
    s_branch L_att
L_aux:
    s_cmp_eq_u32 s37, 2
    s_cbranch_scc1 L_ld
    s_setprio 3
    v_lshrrev_b32 v7, 3, v3
    v_lshl_add_u32 v7, v7, 2, v2
    v_and_b32 v4, 7, v0
    v_lshlrev_b32 v4, 4, v4
    s_cmp_eq_u32 s37, 1
    s_cbranch_scc1 L_f
    s_and_b32 s45, s36, 3
    s_lshr_b32 s44, s36, 2
    s_xor_b32 s44, s44, 3
    s_lshl_b32 s46, s35, 10
    s_lshl_b32 s44, s44, 7
    s_lshl_b32 s47, s45, 20
    s_add_u32 s46, s46, s44
    s_add_u32 s46, s46, s47
    v_lshl_add_u32 v4, v7, 16, v4
    v_add_u32 v4, s46, v4
    v_bfe_u32 v5, v3, 2, 1
    v_lshlrev_b32 v5, 10, v5
    v_lshl_add_u32 v5, v7, 4, v5
    s_lshl_b32 s47, s45, 8
    v_add_u32 v5, s47, v5
    s_movk_i32 s48, 0x2000
    s_waitcnt lgkmcnt(0)
    global_load_dwordx4 v[8:11], v5, s[8:9]
    global_load_dwordx4 v[12:15], v5, s[8:9] offset:128
    global_load_dwordx4 v[16:19], v4, s[14:15] nt
    v_add_u32 v4, s48, v4
    global_load_dwordx4 v[20:23], v4, s[14:15] nt
    v_add_u32 v4, s48, v4
    global_load_dwordx4 v[24:27], v4, s[14:15] nt
    v_add_u32 v4, s48, v4
    global_load_dwordx4 v[28:31], v4, s[14:15] nt
    v_add_u32 v4, s48, v4
    global_load_dwordx4 v[32:35], v4, s[14:15] nt
    v_add_u32 v4, s48, v4
    global_load_dwordx4 v[36:39], v4, s[14:15] nt
    v_add_u32 v4, s48, v4
    global_load_dwordx4 v[40:43], v4, s[14:15] nt
    v_add_u32 v4, s48, v4
    global_load_dwordx4 v[44:47], v4, s[14:15] nt
    v_add_u32 v4, 466944, v4
    global_load_dwordx4 v[48:51], v4, s[14:15] nt
    v_add_u32 v4, s48, v4
    global_load_dwordx4 v[52:55], v4, s[14:15] nt
    v_add_u32 v4, s48, v4
    global_load_dwordx4 v[56:59], v4, s[14:15] nt
    v_add_u32 v4, s48, v4
    global_load_dwordx4 v[60:63], v4, s[14:15] nt
    v_add_u32 v4, s48, v4
    global_load_dwordx4 v[64:67], v4, s[14:15] nt
    v_add_u32 v4, s48, v4
    global_load_dwordx4 v[68:71], v4, s[14:15] nt
    v_add_u32 v4, s48, v4
    global_load_dwordx4 v[72:75], v4, s[14:15] nt
    v_add_u32 v4, s48, v4
    global_load_dwordx4 v[76:79], v4, s[14:15] nt
    s_barrier
    s_barrier
    s_branch L_q2
L_f:
    s_and_b32 s44, s36, 7
    s_lshl_b32 s55, s35, 2
    s_sub_u32 s55, s55, 4
    s_lshr_b32 s45, s36, 3
    s_add_u32 s45, s45, s55
    s_mul_i32 s46, s44, 229376
    s_lshl_b32 s47, s45, 7
    s_add_u32 s46, s46, s47
    v_mul_u32_u24 v5, 28672, v7
    v_add3_u32 v4, v4, v5, s46
    v_and_b32 v5, 1, v3
    v_lshlrev_b32 v5, 10, v5
    v_lshl_add_u32 v5, v7, 4, v5
    s_lshl_b32 s47, s44, 7
    v_add_u32 v5, s47, v5
    v_lshlrev_b32 v6, 4, v0
    s_movk_i32 s48, 3584
    s_cmp_lg_u32 s35, 0
    s_cselect_b32 s54, 32, 0
    s_waitcnt lgkmcnt(0)
    s_barrier
    global_load_dwordx4 v[8:11], v5, s[8:9]
    s_cmp_ge_u32 s36, s54
    s_cbranch_scc1 L_f1
    global_load_dwordx4 v[16:19], v4, s[20:21] nt
    global_load_dwordx4 v[48:51], v4, s[22:23] nt
    v_add_u32 v4, s48, v4
    global_load_dwordx4 v[20:23], v4, s[20:21] nt
    global_load_dwordx4 v[52:55], v4, s[22:23] nt
    v_add_u32 v4, s48, v4
    global_load_dwordx4 v[24:27], v4, s[20:21] nt
    global_load_dwordx4 v[56:59], v4, s[22:23] nt
    v_add_u32 v4, s48, v4
    global_load_dwordx4 v[28:31], v4, s[20:21] nt
    global_load_dwordx4 v[60:63], v4, s[22:23] nt
    v_add_u32 v4, s48, v4
    global_load_dwordx4 v[32:35], v4, s[20:21] nt
    global_load_dwordx4 v[64:67], v4, s[22:23] nt
    v_add_u32 v4, s48, v4
    global_load_dwordx4 v[36:39], v4, s[20:21] nt
    global_load_dwordx4 v[68:71], v4, s[22:23] nt
    v_add_u32 v4, s48, v4
    global_load_dwordx4 v[40:43], v4, s[20:21] nt
    global_load_dwordx4 v[72:75], v4, s[22:23] nt
    v_add_u32 v4, s48, v4
    global_load_dwordx4 v[44:47], v4, s[20:21] nt
    global_load_dwordx4 v[76:79], v4, s[22:23] nt
L_f1:
    global_load_dwordx4 v[96:99], v6, s[8:9]
    global_load_dwordx4 v[100:103], v6, s[8:9] offset:1024
    global_load_dwordx4 v[104:107], v6, s[26:27]
    s_barrier
    s_branch L_f2
L_ld:
    s_setprio 2
    s_lshr_b32 s44, s36, 4
    s_and_b32 s45, s36, 15
    s_lshl_b32 s46, s44, 25
    s_lshl_b32 s47, s35, 22
    s_add_u32 s46, s46, s47
    s_lshl_b32 s47, s45, 16
    s_add_u32 s46, s46, s47
    s_add_u32 s46, s46, 0x300000
    v_lshlrev_b32 v4, 8, v2
    v_add_u32 v4, s46, v4
    v_xor_b32 v5, v3, v2
    v_lshl_add_u32 v8, v5, 4, v4
    v_xor_b32 v9, 64, v8
    v_xor_b32 v10, 0x80, v8
    v_xor_b32 v11, 0xc0, v8
    s_add_u32 s53, s35, s45
    s_and_b32 s53, s53, 15
    s_lshl_b32 s53, s53, 12
    s_mov_b32 s58, 0x4000000
    s_mov_b32 s59, 0x20000
    s_mov_b32 m0, 0
    s_waitcnt lgkmcnt(0)
    s_mov_b32 s56, s10
    s_mov_b32 s57, s11
    s_barrier
    s_barrier
    buffer_load_dwordx4 v8, s[56:59], s53 offen offset:0 nt lds
    buffer_load_dwordx4 v9, s[56:59], s53 offen offset:1024 nt lds
    buffer_load_dwordx4 v10, s[56:59], s53 offen offset:2048 nt lds
    buffer_load_dwordx4 v11, s[56:59], s53 offen offset:3072 nt lds
    s_mov_b32 m0, 4096
    s_add_u32 s53, s53, 0x1000
    s_and_b32 s53, s53, 0xffff
    buffer_load_dwordx4 v8, s[56:59], s53 offen offset:0 nt lds
    buffer_load_dwordx4 v9, s[56:59], s53 offen offset:1024 nt lds
    buffer_load_dwordx4 v10, s[56:59], s53 offen offset:2048 nt lds
    buffer_load_dwordx4 v11, s[56:59], s53 offen offset:3072 nt lds
    s_mov_b32 m0, 8192
    s_add_u32 s53, s53, 0x1000
    s_and_b32 s53, s53, 0xffff
    buffer_load_dwordx4 v8, s[56:59], s53 offen offset:0 nt lds
    buffer_load_dwordx4 v9, s[56:59], s53 offen offset:1024 nt lds
    buffer_load_dwordx4 v10, s[56:59], s53 offen offset:2048 nt lds
    buffer_load_dwordx4 v11, s[56:59], s53 offen offset:3072 nt lds
    s_mov_b32 m0, 12288
    s_add_u32 s53, s53, 0x1000
    s_and_b32 s53, s53, 0xffff
    buffer_load_dwordx4 v8, s[56:59], s53 offen offset:0 nt lds
    buffer_load_dwordx4 v9, s[56:59], s53 offen offset:1024 nt lds
    buffer_load_dwordx4 v10, s[56:59], s53 offen offset:2048 nt lds
    buffer_load_dwordx4 v11, s[56:59], s53 offen offset:3072 nt lds
    s_mov_b32 m0, 16384
    s_add_u32 s53, s53, 0x1000
    s_and_b32 s53, s53, 0xffff
    s_mov_b32 s60, s12
    s_mov_b32 s61, s13
    s_mov_b32 s62, 0x4000000
    s_mov_b32 s63, 0x20000
    v_lshlrev_b32 v6, 1, v2
    v_xor_b32 v6, v3, v6
    v_lshlrev_b32 v6, 4, v6
    v_add_u32 v12, v4, v6
    v_xor_b32 v13, 0x80, v12
    s_and_b32 s54, s36, 7
    s_lshr_b32 s55, s36, 3
    s_max_u32 s46, s35, 1
    s_lshl_b32 s46, s46, 2
    s_sub_u32 s46, s46, 4
    s_lshr_b32 s47, s54, 1
    s_add_u32 s47, s47, s46
    s_lshl_b32 s47, s47, 16
    s_and_b32 s46, s54, 1
    s_lshl_b32 s46, s46, 11
    s_add_u32 s46, s46, s47
    s_lshl_b32 s48, s55, 8
    s_add_u32 s46, s46, s48
    v_lshl_add_u32 v14, v2, 13, v6
    v_add_u32 v14, s46, v14
    v_xor_b32 v15, 0x80, v14
    s_lshl_b32 s46, s35, 19
    s_lshl_b32 s47, s54, 14
    s_add_u32 s46, s46, s47
    s_add_u32 s46, s46, s48
    v_lshl_add_u32 v16, v2, 10, v6
    v_add_u32 v16, s46, v16
    v_xor_b32 v17, 0x80, v16
    s_mov_b32 s40, s24
    s_mov_b32 s41, s25
    s_cmp_lg_u32 s35, 0
    s_cselect_b32 s42, 1835008, 0
    s_mov_b32 s43, 0x20000
    s_mov_b32 s44, s16
    s_mov_b32 s45, s17
    s_mov_b32 s46, 0x400000
    s_mov_b32 s47, 0x20000
    v_mov_b32 v18, 158992
    s_waitcnt vmcnt(15)
    buffer_load_dwordx4 v8, s[56:59], s53 offen offset:0 nt lds
    buffer_load_dwordx4 v9, s[56:59], s53 offen offset:1024 nt lds
    buffer_load_dwordx4 v10, s[56:59], s53 offen offset:2048 nt lds
    buffer_load_dwordx4 v11, s[56:59], s53 offen offset:3072 nt lds
    s_mov_b32 m0, 20480
    s_add_u32 s53, s53, 0x1000
    s_and_b32 s53, s53, 0xffff
    buffer_load_dwordx4 v8, s[56:59], s53 offen offset:0 nt lds
    buffer_load_dwordx4 v9, s[56:59], s53 offen offset:1024 nt lds
    s_waitcnt vmcnt(21)
    buffer_load_dwordx4 v10, s[56:59], s53 offen offset:2048 nt lds
    s_waitcnt vmcnt(21)
    buffer_load_dwordx4 v11, s[56:59], s53 offen offset:3072 nt lds
    s_mov_b32 m0, 24576
    s_add_u32 s53, s53, 0x1000
    s_and_b32 s53, s53, 0xffff
    s_waitcnt vmcnt(21)
    buffer_load_dwordx4 v8, s[56:59], s53 offen offset:0 nt lds
    s_waitcnt vmcnt(21)
    buffer_load_dwordx4 v9, s[56:59], s53 offen offset:1024 nt lds
    s_waitcnt vmcnt(21)
    buffer_load_dwordx4 v10, s[56:59], s53 offen offset:2048 nt lds
    s_waitcnt vmcnt(21)
    buffer_load_dwordx4 v11, s[56:59], s53 offen offset:3072 nt lds
    s_mov_b32 m0, 28672
    s_add_u32 s53, s53, 0x1000
    s_and_b32 s53, s53, 0xffff
    s_waitcnt vmcnt(21)
    buffer_load_dwordx4 v8, s[56:59], s53 offen offset:0 nt lds
    s_waitcnt vmcnt(21)
    buffer_load_dwordx4 v9, s[56:59], s53 offen offset:1024 nt lds
    s_waitcnt vmcnt(21)
    buffer_load_dwordx4 v10, s[56:59], s53 offen offset:2048 nt lds
    s_waitcnt vmcnt(21)
    buffer_load_dwordx4 v11, s[56:59], s53 offen offset:3072 nt lds
    s_mov_b32 m0, 32768
    s_add_u32 s53, s53, 0x1000
    s_and_b32 s53, s53, 0xffff
    s_waitcnt vmcnt(21)
    buffer_load_dwordx4 v8, s[56:59], s53 offen offset:0 nt lds
    s_waitcnt vmcnt(21)
    buffer_load_dwordx4 v9, s[56:59], s53 offen offset:1024 nt lds
    s_waitcnt vmcnt(21)
    buffer_load_dwordx4 v10, s[56:59], s53 offen offset:2048 nt lds
    s_waitcnt vmcnt(21)
    buffer_load_dwordx4 v11, s[56:59], s53 offen offset:3072 nt lds
    s_mov_b32 m0, 36864
    s_add_u32 s53, s53, 0x1000
    s_and_b32 s53, s53, 0xffff
    s_waitcnt vmcnt(21)
    buffer_load_dwordx4 v8, s[56:59], s53 offen offset:0 nt lds
    s_waitcnt vmcnt(21)
    buffer_load_dwordx4 v9, s[56:59], s53 offen offset:1024 nt lds
    s_waitcnt vmcnt(21)
    buffer_load_dwordx4 v10, s[56:59], s53 offen offset:2048 nt lds
    s_waitcnt vmcnt(21)
    buffer_load_dwordx4 v11, s[56:59], s53 offen offset:3072 nt lds
    s_mov_b32 m0, 40960
    s_add_u32 s53, s53, 0x1000
    s_and_b32 s53, s53, 0xffff
    s_waitcnt vmcnt(21)
    buffer_load_dwordx4 v8, s[56:59], s53 offen offset:0 nt lds
    s_waitcnt vmcnt(21)
    buffer_load_dwordx4 v9, s[56:59], s53 offen offset:1024 nt lds
    s_waitcnt vmcnt(21)
    buffer_load_dwordx4 v10, s[56:59], s53 offen offset:2048 nt lds
    s_waitcnt vmcnt(21)
    buffer_load_dwordx4 v11, s[56:59], s53 offen offset:3072 nt lds
    s_mov_b32 m0, 45056
    s_add_u32 s53, s53, 0x1000
    s_and_b32 s53, s53, 0xffff
    s_waitcnt vmcnt(21)
    buffer_load_dwordx4 v8, s[56:59], s53 offen offset:0 nt lds
    s_waitcnt vmcnt(21)
    buffer_load_dwordx4 v9, s[56:59], s53 offen offset:1024 nt lds
    s_waitcnt vmcnt(21)
    buffer_load_dwordx4 v10, s[56:59], s53 offen offset:2048 nt lds
    s_waitcnt vmcnt(21)
    buffer_load_dwordx4 v11, s[56:59], s53 offen offset:3072 nt lds
    s_mov_b32 m0, 49152
    s_add_u32 s53, s53, 0x1000
    s_and_b32 s53, s53, 0xffff
    s_waitcnt vmcnt(21)
    buffer_load_dwordx4 v8, s[56:59], s53 offen offset:0 nt lds
    s_waitcnt vmcnt(21)
    buffer_load_dwordx4 v9, s[56:59], s53 offen offset:1024 nt lds
    s_waitcnt vmcnt(21)
    buffer_load_dwordx4 v10, s[56:59], s53 offen offset:2048 nt lds
    s_waitcnt vmcnt(21)
    buffer_load_dwordx4 v11, s[56:59], s53 offen offset:3072 nt lds
    s_mov_b32 m0, 53248
    s_add_u32 s53, s53, 0x1000
    s_and_b32 s53, s53, 0xffff
    s_waitcnt vmcnt(21)
    buffer_load_dwordx4 v8, s[56:59], s53 offen offset:0 nt lds
    s_waitcnt vmcnt(21)
    buffer_load_dwordx4 v9, s[56:59], s53 offen offset:1024 nt lds
    s_waitcnt vmcnt(21)
    buffer_load_dwordx4 v10, s[56:59], s53 offen offset:2048 nt lds
    s_waitcnt vmcnt(21)
    buffer_load_dwordx4 v11, s[56:59], s53 offen offset:3072 nt lds
    s_mov_b32 m0, 57344
    s_add_u32 s53, s53, 0x1000
    s_and_b32 s53, s53, 0xffff
    s_waitcnt vmcnt(21)
    buffer_load_dwordx4 v8, s[56:59], s53 offen offset:0 nt lds
    s_waitcnt vmcnt(21)
    buffer_load_dwordx4 v9, s[56:59], s53 offen offset:1024 nt lds
    s_waitcnt vmcnt(21)
    buffer_load_dwordx4 v10, s[56:59], s53 offen offset:2048 nt lds
    s_waitcnt vmcnt(21)
    buffer_load_dwordx4 v11, s[56:59], s53 offen offset:3072 nt lds
    s_mov_b32 m0, 61440
    s_add_u32 s53, s53, 0x1000
    s_and_b32 s53, s53, 0xffff
    s_waitcnt vmcnt(21)
    buffer_load_dwordx4 v8, s[56:59], s53 offen offset:0 nt lds
    s_waitcnt vmcnt(21)
    buffer_load_dwordx4 v9, s[56:59], s53 offen offset:1024 nt lds
    s_waitcnt vmcnt(21)
    buffer_load_dwordx4 v10, s[56:59], s53 offen offset:2048 nt lds
    s_waitcnt vmcnt(21)
    buffer_load_dwordx4 v11, s[56:59], s53 offen offset:3072 nt lds
    s_mov_b32 m0, 65536
    s_add_u32 s53, s53, 0x1000
    s_and_b32 s53, s53, 0xffff
    s_waitcnt vmcnt(21)
    buffer_load_dwordx4 v12, s[60:63], s53 offen offset:0 nt lds
    s_waitcnt vmcnt(21)
    buffer_load_dwordx4 v13, s[60:63], s53 offen offset:1024 nt lds
    s_waitcnt vmcnt(21)
    buffer_load_dwordx4 v12, s[60:63], s53 offen offset:2048 nt lds
    s_waitcnt vmcnt(21)
    buffer_load_dwordx4 v13, s[60:63], s53 offen offset:3072 nt lds
    s_mov_b32 m0, 69632
    s_add_u32 s53, s53, 0x1000
    s_and_b32 s53, s53, 0xffff
    s_waitcnt vmcnt(21)
    buffer_load_dwordx4 v12, s[60:63], s53 offen offset:0 nt lds
    s_waitcnt vmcnt(21)
    buffer_load_dwordx4 v13, s[60:63], s53 offen offset:1024 nt lds
    s_waitcnt vmcnt(21)
    buffer_load_dwordx4 v12, s[60:63], s53 offen offset:2048 nt lds
    s_waitcnt vmcnt(21)
    buffer_load_dwordx4 v13, s[60:63], s53 offen offset:3072 nt lds
    s_mov_b32 m0, 73728
    s_add_u32 s53, s53, 0x1000
    s_and_b32 s53, s53, 0xffff
    s_waitcnt vmcnt(21)
    buffer_load_dwordx4 v12, s[60:63], s53 offen offset:0 nt lds
    s_waitcnt vmcnt(21)
    buffer_load_dwordx4 v13, s[60:63], s53 offen offset:1024 nt lds
    s_waitcnt vmcnt(21)
    buffer_load_dwordx4 v12, s[60:63], s53 offen offset:2048 nt lds
    s_waitcnt vmcnt(21)
    buffer_load_dwordx4 v13, s[60:63], s53 offen offset:3072 nt lds
    s_mov_b32 m0, 77824
    s_add_u32 s53, s53, 0x1000
    s_and_b32 s53, s53, 0xffff
    s_waitcnt vmcnt(21)
    buffer_load_dwordx4 v12, s[60:63], s53 offen offset:0 nt lds
    s_waitcnt vmcnt(21)
    buffer_load_dwordx4 v13, s[60:63], s53 offen offset:1024 nt lds
    s_waitcnt vmcnt(21)
    buffer_load_dwordx4 v12, s[60:63], s53 offen offset:2048 nt lds
    s_waitcnt vmcnt(21)
    buffer_load_dwordx4 v13, s[60:63], s53 offen offset:3072 nt lds
    s_mov_b32 m0, 81920
    s_add_u32 s53, s53, 0x1000
    s_and_b32 s53, s53, 0xffff
    s_waitcnt vmcnt(21)
    buffer_load_dwordx4 v12, s[60:63], s53 offen offset:0 nt lds
    s_waitcnt vmcnt(21)
    buffer_load_dwordx4 v13, s[60:63], s53 offen offset:1024 nt lds
    s_waitcnt vmcnt(21)
    buffer_load_dwordx4 v12, s[60:63], s53 offen offset:2048 nt lds
    s_waitcnt vmcnt(21)
    buffer_load_dwordx4 v13, s[60:63], s53 offen offset:3072 nt lds
    s_mov_b32 m0, 86016
    s_add_u32 s53, s53, 0x1000
    s_and_b32 s53, s53, 0xffff
    s_waitcnt vmcnt(21)
    buffer_load_dwordx4 v12, s[60:63], s53 offen offset:0 nt lds
    s_waitcnt vmcnt(21)
    ds_write_b32 v18, v18 offset:4
    buffer_load_dwordx4 v13, s[60:63], s53 offen offset:1024 nt lds
    s_waitcnt vmcnt(21)
    buffer_load_dwordx4 v12, s[60:63], s53 offen offset:2048 nt lds
    s_waitcnt vmcnt(21)
    buffer_load_dwordx4 v13, s[60:63], s53 offen offset:3072 nt lds
    s_mov_b32 m0, 90112
    s_add_u32 s53, s53, 0x1000
    s_and_b32 s53, s53, 0xffff
    s_waitcnt vmcnt(21)
    buffer_load_dwordx4 v12, s[60:63], s53 offen offset:0 nt lds
    s_waitcnt vmcnt(21)
    buffer_load_dwordx4 v13, s[60:63], s53 offen offset:1024 nt lds
    s_waitcnt vmcnt(21)
    buffer_load_dwordx4 v12, s[60:63], s53 offen offset:2048 nt lds
    s_waitcnt vmcnt(21)
    buffer_load_dwordx4 v13, s[60:63], s53 offen offset:3072 nt lds
    s_mov_b32 m0, 94208
    s_add_u32 s53, s53, 0x1000
    s_and_b32 s53, s53, 0xffff
    s_waitcnt vmcnt(21)
    buffer_load_dwordx4 v12, s[60:63], s53 offen offset:0 nt lds
    s_waitcnt vmcnt(21)
    buffer_load_dwordx4 v13, s[60:63], s53 offen offset:1024 nt lds
    s_waitcnt vmcnt(21)
    buffer_load_dwordx4 v12, s[60:63], s53 offen offset:2048 nt lds
    s_waitcnt vmcnt(21)
    buffer_load_dwordx4 v13, s[60:63], s53 offen offset:3072 nt lds
    s_mov_b32 m0, 98304
    s_add_u32 s53, s53, 0x1000
    s_and_b32 s53, s53, 0xffff
    s_waitcnt vmcnt(21)
    buffer_load_dwordx4 v12, s[60:63], s53 offen offset:0 nt lds
    s_waitcnt vmcnt(21)
    buffer_load_dwordx4 v13, s[60:63], s53 offen offset:1024 nt lds
    s_waitcnt vmcnt(21)
    buffer_load_dwordx4 v12, s[60:63], s53 offen offset:2048 nt lds
    s_waitcnt vmcnt(21)
    buffer_load_dwordx4 v13, s[60:63], s53 offen offset:3072 nt lds
    s_mov_b32 m0, 102400
    s_add_u32 s53, s53, 0x1000
    s_and_b32 s53, s53, 0xffff
    s_waitcnt vmcnt(21)
    buffer_load_dwordx4 v12, s[60:63], s53 offen offset:0 nt lds
    s_waitcnt vmcnt(21)
    buffer_load_dwordx4 v13, s[60:63], s53 offen offset:1024 nt lds
    s_waitcnt vmcnt(21)
    buffer_load_dwordx4 v12, s[60:63], s53 offen offset:2048 nt lds
    s_waitcnt vmcnt(21)
    buffer_load_dwordx4 v13, s[60:63], s53 offen offset:3072 nt lds
    s_mov_b32 m0, 106496
    s_add_u32 s53, s53, 0x1000
    s_and_b32 s53, s53, 0xffff
    s_waitcnt vmcnt(21)
    s_load_dword s49, s[30:31], 0
    s_mov_b32 s50, 1000000
    buffer_load_dwordx4 v12, s[60:63], s53 offen offset:0 nt lds
    s_waitcnt vmcnt(21)
    buffer_load_dwordx4 v13, s[60:63], s53 offen offset:1024 nt lds
    s_waitcnt vmcnt(21)
    buffer_load_dwordx4 v12, s[60:63], s53 offen offset:2048 nt lds
    s_waitcnt vmcnt(21)
    buffer_load_dwordx4 v13, s[60:63], s53 offen offset:3072 nt lds
    s_mov_b32 m0, 110592
    s_add_u32 s53, s53, 0x1000
    s_and_b32 s53, s53, 0xffff
    s_waitcnt vmcnt(21)
    buffer_load_dwordx4 v12, s[60:63], s53 offen offset:0 nt lds
    s_waitcnt vmcnt(21)
    buffer_load_dwordx4 v13, s[60:63], s53 offen offset:1024 nt lds
    s_waitcnt vmcnt(21)
    buffer_load_dwordx4 v12, s[60:63], s53 offen offset:2048 nt lds
    s_waitcnt vmcnt(21)
    buffer_load_dwordx4 v13, s[60:63], s53 offen offset:3072 nt lds
    s_mov_b32 m0, 114688
    s_add_u32 s53, s53, 0x1000
    s_and_b32 s53, s53, 0xffff
    s_waitcnt vmcnt(21)
    buffer_load_dwordx4 v12, s[60:63], s53 offen offset:0 nt lds
    s_waitcnt vmcnt(21)
    buffer_load_dwordx4 v13, s[60:63], s53 offen offset:1024 nt lds
    s_waitcnt vmcnt(21)
    buffer_load_dwordx4 v12, s[60:63], s53 offen offset:2048 nt lds
    s_waitcnt vmcnt(21)
    buffer_load_dwordx4 v13, s[60:63], s53 offen offset:3072 nt lds
    s_mov_b32 m0, 118784
    s_add_u32 s53, s53, 0x1000
    s_and_b32 s53, s53, 0xffff
    s_waitcnt vmcnt(21)
    buffer_load_dwordx4 v12, s[60:63], s53 offen offset:0 nt lds
    s_waitcnt vmcnt(21)
    buffer_load_dwordx4 v13, s[60:63], s53 offen offset:1024 nt lds
    s_waitcnt vmcnt(21)
    buffer_load_dwordx4 v12, s[60:63], s53 offen offset:2048 nt lds
    s_waitcnt vmcnt(21)
    buffer_load_dwordx4 v13, s[60:63], s53 offen offset:3072 nt lds
    s_mov_b32 m0, 122880
    s_add_u32 s53, s53, 0x1000
    s_and_b32 s53, s53, 0xffff
    s_waitcnt vmcnt(21)
    buffer_load_dwordx4 v12, s[60:63], s53 offen offset:0 nt lds
    s_waitcnt vmcnt(21)
    buffer_load_dwordx4 v13, s[60:63], s53 offen offset:1024 nt lds
    s_waitcnt vmcnt(21)
    buffer_load_dwordx4 v12, s[60:63], s53 offen offset:2048 nt lds
    s_waitcnt vmcnt(21)
    buffer_load_dwordx4 v13, s[60:63], s53 offen offset:3072 nt lds
    s_mov_b32 m0, 126976
    s_add_u32 s53, s53, 0x1000
    s_and_b32 s53, s53, 0xffff
    s_waitcnt vmcnt(21)
    buffer_load_dwordx4 v12, s[60:63], s53 offen offset:0 nt lds
    s_waitcnt vmcnt(21)
    ds_write_b32 v18, v18 offset:8
    buffer_load_dwordx4 v13, s[60:63], s53 offen offset:1024 nt lds
    s_waitcnt vmcnt(21)
    buffer_load_dwordx4 v12, s[60:63], s53 offen offset:2048 nt lds
    s_waitcnt vmcnt(21)
    buffer_load_dwordx4 v13, s[60:63], s53 offen offset:3072 nt lds
    s_mov_b32 m0, 131072
    s_add_u32 s53, s53, 0x1000
    s_and_b32 s53, s53, 0xffff
    s_mov_b32 s52, 0
    s_waitcnt vmcnt(21)
    buffer_load_dwordx4 v16, s[44:47], s52 offen nt lds
    s_mov_b32 m0, 132096
    s_mov_b32 s52, 131072
    s_waitcnt vmcnt(21)
    buffer_load_dwordx4 v17, s[44:47], s52 offen nt lds
    s_mov_b32 m0, 133120
    s_mov_b32 s52, 262144
    s_waitcnt vmcnt(21)
    buffer_load_dwordx4 v16, s[44:47], s52 offen nt lds
    s_mov_b32 m0, 134144
    s_mov_b32 s52, 393216
    s_waitcnt vmcnt(21)
    buffer_load_dwordx4 v17, s[44:47], s52 offen nt lds
    s_mov_b32 m0, 135168
    s_mov_b32 s52, 4096
    s_waitcnt vmcnt(21)
    buffer_load_dwordx4 v16, s[44:47], s52 offen nt lds
    s_mov_b32 m0, 136192
    s_mov_b32 s52, 135168
    s_waitcnt vmcnt(21)
    buffer_load_dwordx4 v17, s[44:47], s52 offen nt lds
    s_mov_b32 m0, 137216
    s_mov_b32 s52, 266240
    s_waitcnt vmcnt(21)
    buffer_load_dwordx4 v16, s[44:47], s52 offen nt lds
    s_mov_b32 m0, 138240
    s_mov_b32 s52, 397312
    s_waitcnt vmcnt(21)
    buffer_load_dwordx4 v17, s[44:47], s52 offen nt lds
    s_mov_b32 m0, 139264
    s_mov_b32 s52, 8192
    s_waitcnt vmcnt(21)
    buffer_load_dwordx4 v16, s[44:47], s52 offen nt lds
    s_mov_b32 m0, 140288
    s_mov_b32 s52, 139264
    s_waitcnt vmcnt(21)
    buffer_load_dwordx4 v17, s[44:47], s52 offen nt lds
    s_mov_b32 m0, 141312
    s_mov_b32 s52, 270336
    s_waitcnt vmcnt(21)
    buffer_load_dwordx4 v16, s[44:47], s52 offen nt lds
    s_mov_b32 m0, 142336
    s_mov_b32 s52, 401408
    s_waitcnt vmcnt(21)
    buffer_load_dwordx4 v17, s[44:47], s52 offen nt lds
    s_mov_b32 m0, 143360
    s_mov_b32 s52, 12288
    buffer_load_dwordx4 v16, s[44:47], s52 offen nt lds
    s_mov_b32 m0, 144384
    s_mov_b32 s52, 143360
    buffer_load_dwordx4 v17, s[44:47], s52 offen nt lds
    s_mov_b32 m0, 145408
    s_mov_b32 s52, 274432
    buffer_load_dwordx4 v16, s[44:47], s52 offen nt lds
    s_mov_b32 m0, 146432
    s_mov_b32 s52, 405504
    buffer_load_dwordx4 v17, s[44:47], s52 offen nt lds
    s_mov_b32 m0, 147456
    s_mov_b32 s52, 0
    buffer_load_dwordx4 v14, s[40:43], s52 offen nt lds
    s_mov_b32 m0, 148480
    s_mov_b32 s52, 32768
    buffer_load_dwordx4 v15, s[40:43], s52 offen nt lds
    s_mov_b32 m0, 149504
    s_mov_b32 s52, 4096
    buffer_load_dwordx4 v14, s[40:43], s52 offen nt lds
    s_mov_b32 m0, 150528
    s_mov_b32 s52, 36864
    buffer_load_dwordx4 v15, s[40:43], s52 offen nt lds
    s_mov_b32 m0, 151552
    s_mov_b32 s52, 1024
    buffer_load_dwordx4 v14, s[40:43], s52 offen nt lds
    s_mov_b32 m0, 152576
    s_mov_b32 s52, 33792
    buffer_load_dwordx4 v15, s[40:43], s52 offen nt lds
    s_mov_b32 m0, 153600
    s_mov_b32 s52, 5120
    buffer_load_dwordx4 v14, s[40:43], s52 offen nt lds
    s_mov_b32 m0, 154624
    s_mov_b32 s52, 37888
    buffer_load_dwordx4 v15, s[40:43], s52 offen nt lds
L_nget:
    s_waitcnt lgkmcnt(0)
    s_bitcmp1_b32 s49, 21
    s_cbranch_scc1 L_ngot
    s_sub_u32 s50, s50, 1
    s_bitcmp1_b32 s50, 31
    s_cbranch_scc1 L_ngot
    s_sleep 8
    s_mov_b32 s49, 0
    s_atomic_add s49, s[30:31], 0 glc
    s_branch L_nget
L_ngot:
    s_and_b32 s49, s49, 0xffff
    s_cmp_ge_u32 s49, 16
    s_cselect_b32 s49, 0, 0x2000
    v_mov_b32 v10, s49
    ds_write_b32 v18, v10 offset:400
    s_waitcnt lgkmcnt(0)
    s_waitcnt vmcnt(24)
    s_barrier
    s_waitcnt vmcnt(0)
    s_barrier
    s_endpgm
L_att:
    s_sub_u32 s37, s37, 3
    s_sub_u32 s43, 0, s32
    s_and_b32 s43, s43, 0x3f80
    s_or_b32 s44, s35, s37
    s_cbranch_scc1 L_norace
    s_lshl_b32 s44, s36, 8
    s_add_u32 s44, s44, s43
    s_add_u32 s44, s44, 1851392
    s_and_b32 s45, s36, 1
    s_lshl_b32 s46, s45, 13
    s_add_u32 s47, s44, s46
    s_xor_b32 s46, s46, 0x2000
    s_add_u32 s46, s44, s46
    s_load_dword s58, s[32:33], s47
    s_load_dword s59, s[32:33], s46
    s_waitcnt lgkmcnt(1)
    s_sleep 1
    s_getreg_b32 s46, hwreg(HW_REG_IB_STS, 8, 1)
    s_xor_b32 s46, s46, s45
    s_add_u32 s46, s46, 0x10000
    s_waitcnt lgkmcnt(0)
    s_atomic_add s46, s[30:31], 0 glc
    s_waitcnt lgkmcnt(0)
L_norace:
    s_load_dword s34, s[32:33], 0
    s_lshl_b32 s52, s37, 10
    s_lshl_b32 s51, s37, 13
    s_mov_b32 s38, 0xfffffc00
    s_mov_b32 s50, 1000000
    s_and_b32 s54, s36, 7
    s_lshr_b32 s55, s36, 3
    s_lshl_b32 s42, s35, 3
    s_add_u32 s42, s42, s54
    s_lshr_b32 s44, s37, 2
    v_and_b32 v7, 3, v3
    s_lshl_b32 s46, s35, 8
    s_lshl_b32 s47, s37, 5
    s_add_u32 s47, s47, s46
    s_add_u32 s47, s47, s36
    s_lshl_b32 s45, s47, 8
    s_add_u32 s45, s45, 364544
    v_lshlrev_b32 v10, 4, v7
    v_lshl_add_u32 v102, v2, 6, v10
    v_add_u32 v102, s45, v102
    s_lshl_b32 s45, s47, 5
    s_add_u32 s45, s45, 1150976
    v_lshl_add_u32 v103, v7, 3, s45
    s_lshl_b32 s47, s42, 5
    s_lshl_b32 s46, s44, 4
    s_add_u32 s47, s47, s46
    s_lshl_b32 s45, s47, 5
    s_add_u32 s45, s45, 1150976
    v_lshl_add_u32 v105, v0, 3, s45
    s_lshl_b32 s45, s47, 8
    s_and_b32 s46, s37, 3
    s_lshl_b32 s46, s46, 6
    s_add_u32 s45, s45, s46
    s_add_u32 s45, s45, 364544
    v_lshrrev_b32 v106, 2, v0
    v_lshl_add_u32 v104, v106, 8, v10
    v_add_u32 v104, s45, v104
    v_and_b32 v4, 1, v0
    s_lshl_b32 s47, s36, 14
    s_add_u32 s47, s47, s43
    s_add_u32 s47, s47, s52
    s_add_u32 s47, s47, 1310720
    v_lshl_add_u32 v116, v0, 4, s47
    v_and_b32 v117, 7, v0
    v_lshl_add_u32 v117, v117, 2, v2
    s_lshl_b32 s47, s37, 2
    s_add_u32 s47, s47, 156672
    v_lshl_add_u32 v117, v117, 5, s47
    v_and_b32 v119, 31, v0
    v_lshlrev_b32 v118, 5, v119
    v_add_u32 v118, 156672, v118
    s_lshl_b32 s46, s36, 5
    v_and_b32 v119, 30, v119
    v_lshl_add_u32 v119, v4, 10, v119
    v_add_u32 v119, s46, v119
    v_xor_b32 v5, v3, v2
    v_lshlrev_b32 v5, 4, v5
    v_lshl_add_u32 v120, v3, 8, v5
    v_add_u32 v120, s51, v120
    v_xor_b32 v121, 64, v120
    v_xor_b32 v122, 0x80, v120
    v_xor_b32 v123, 0xc0, v120
    v_lshlrev_b32 v8, 8, v7
    v_lshl_add_u32 v8, v2, 4, v8
    v_add_u32 v8, 155648, v8
    v_lshlrev_b32 v9, 5, v7
    v_add_u32 v9, 158720, v9
    s_lshl_b32 s47, s37, 2
    v_add_u32 v12, s47, v9
    v_lshl_add_u32 v11, v2, 6, v10
    v_add_u32 v11, 156672, v11
    s_lshl_b32 s47, s37, 8
    v_add_u32 v13, s47, v11
    v_and_b32 v15, 7, v106
    v_lshlrev_b32 v15, 1, v15
    v_lshrrev_b32 v73, 1, v7
    s_lshl_b32 s47, s37, 1
    v_add_u32 v73, s47, v73
    v_xor_b32 v15, v15, v73
    v_lshlrev_b32 v15, 4, v15
    v_lshl_add_u32 v14, v106, 8, v15
    v_lshl_add_u32 v14, v4, 3, v14
    v_add_u32 v14, 65536, v14
    v_add_u32 v5, 65536, v14
    s_mov_b32 s49, 0xffff0000
    s_mov_b32 s48, 0x3db504f3
    s_lshr_b32 s46, s37, 1
    s_lshl_b32 s46, s46, 6
    s_and_b32 s47, s37, 1
    s_lshl_b32 s47, s47, 3
    s_add_u32 s46, s46, s47
    s_add_u32 s46, s46, 159008
    v_lshl_add_u32 v108, v2, 1, v10
    v_add_u32 v108, s46, v108
    v_lshlrev_b32 v70, 4, v2
    v_lshl_add_u32 v109, v4, 7, v70
    v_add_u32 v109, 159008, v109
    v_lshl_add_u32 v110, v4, 6, v70
    v_add_u32 v110, 159264, v110
    s_lshl_b32 s46, s55, 16
    s_add_u32 s46, s46, s51
    s_lshl_b32 s46, s46, 1
    s_add_u32 s46, s46, s43
    s_lshl_b32 s47, s42, 7
    s_add_u32 s46, s46, s47
    s_add_u32 s46, s46, 1310720
    v_lshl_add_u32 v111, v0, 3, s46
    v_mov_b32 v15, 158976
    s_waitcnt vmcnt(0)
    s_waitcnt lgkmcnt(0)
    s_add_u32 s34, s34, 1
    s_and_b32 s41, s34, 0x3ff
    v_mov_b32 v6, s41
    s_bfe_u32 s40, s34, 0xa000a
    v_mov_b32 v100, s40
L_w1:
    ds_read_b64 v[84:85], v15 offset:16
    s_waitcnt lgkmcnt(0)
    v_max_u32 v1, v84, v85
    v_cmp_eq_u32 vcc, -1, v1
    s_cbranch_vccz L_w1_ok
    s_sub_u32 s50, s50, 1
    s_bitcmp1_b32 s50, 31
    s_cbranch_scc1 L_w1_ok
    s_sleep 2
    s_branch L_w1
L_w1_ok:
    ds_read_b128 v[48:51], v8 offset:0
    ds_read_b128 v[16:19], v120 offset:0
    ds_read_b128 v[32:35], v120 offset:4096
    ds_read_b128 v[52:55], v8 offset:64
    ds_read_b128 v[20:23], v121 offset:0
    ds_read_b128 v[36:39], v121 offset:4096
    ds_read_b128 v[56:59], v8 offset:128
    ds_read_b128 v[24:27], v122 offset:0
    ds_read_b128 v[40:43], v122 offset:4096
    ds_read_b128 v[60:63], v8 offset:192
    ds_read_b128 v[28:31], v123 offset:0
    ds_read_b128 v[44:47], v123 offset:4096
    v_readfirstlane_b32 s3, v84
    s_nop 1
    s_cmp_eq_u32 s35, 0
    s_cselect_b32 s53, s3, 0
    s_cmp_eq_u32 s37, s35
    s_cselect_b32 s56, s3, 0
    s_waitcnt lgkmcnt(9)
    v_mfma_f32_16x16x32_bf16 v[64:67], v[16:19], v[48:51], 0
    v_mfma_f32_16x16x32_bf16 v[68:71], v[32:35], v[48:51], 0
    s_waitcnt lgkmcnt(6)
    v_mfma_f32_16x16x32_bf16 v[64:67], v[20:23], v[52:55], v[64:67]
    v_mfma_f32_16x16x32_bf16 v[68:71], v[36:39], v[52:55], v[68:71]
    s_waitcnt lgkmcnt(3)
    v_mfma_f32_16x16x32_bf16 v[64:67], v[24:27], v[56:59], v[64:67]
    v_mfma_f32_16x16x32_bf16 v[68:71], v[40:43], v[56:59], v[68:71]
    s_waitcnt lgkmcnt(0)
    v_mfma_f32_16x16x32_bf16 v[64:67], v[28:31], v[60:63], v[64:67]
    v_mfma_f32_16x16x32_bf16 v[68:71], v[44:47], v[60:63], v[68:71]
    s_nop 6
    v_cvt_pk_bf16_f32 v64, v64, v65
    v_cvt_pk_bf16_f32 v66, v66, v67
    v_cvt_pk_bf16_f32 v68, v68, v69
    v_cvt_pk_bf16_f32 v70, v70, v71
    v_and_b32 v65, s49, v64
    v_lshlrev_b32 v64, 16, v64
    v_and_b32 v67, s49, v66
    v_lshlrev_b32 v66, 16, v66
    v_and_b32 v69, s49, v68
    v_lshlrev_b32 v68, 16, v68
    v_and_b32 v71, s49, v70
    v_lshlrev_b32 v70, 16, v70
    v_pk_mul_f32 v[64:65], v[64:65], s[48:49] op_sel_hi:[1,0]
    v_pk_mul_f32 v[66:67], v[66:67], s[48:49] op_sel_hi:[1,0]
    v_pk_mul_f32 v[68:69], v[68:69], s[48:49] op_sel_hi:[1,0]
    v_pk_mul_f32 v[70:71], v[70:71], s[48:49] op_sel_hi:[1,0]
    v_cvt_pk_bf16_f32 v64, v64, v65
    v_cvt_pk_bf16_f32 v66, v66, v67
    v_cvt_pk_bf16_f32 v68, v68, v69
    v_cvt_pk_bf16_f32 v70, v70, v71
    v_and_b32 v65, s49, v64
    v_lshlrev_b32 v64, 16, v64
    v_and_b32 v67, s49, v66
    v_lshlrev_b32 v66, 16, v66
    v_and_b32 v69, s49, v68
    v_lshlrev_b32 v68, 16, v68
    v_and_b32 v71, s49, v70
    v_lshlrev_b32 v70, 16, v70
    v_max3_f32 v72, v64, v65, v66
    v_max3_f32 v73, v67, v68, v69
    v_max3_f32 v72, v72, v70, v71
    v_max_f32 v72, v72, v73
    v_mov_b32 v73, v72
    s_nop 1
    v_permlane16_swap_b32 v72, v73
    v_max_f32 v72, v72, v73
    v_mov_b32 v73, v72
    s_nop 1
    v_permlane32_swap_b32 v72, v73
    v_max_f32 v72, v72, v73
    ds_write_b32 v12, v72
    s_mov_b32 s48, 0x3fb8aa3b
    v_pk_mul_f32 v[64:65], v[64:65], s[48:49] op_sel_hi:[1,0]
    v_pk_mul_f32 v[66:67], v[66:67], s[48:49] op_sel_hi:[1,0]
    v_pk_mul_f32 v[68:69], v[68:69], s[48:49] op_sel_hi:[1,0]
    v_pk_mul_f32 v[70:71], v[70:71], s[48:49] op_sel_hi:[1,0]
L_w2:
    ds_read_b128 v[72:75], v9
    ds_read_b128 v[76:79], v9 offset:16
    s_waitcnt lgkmcnt(0)
    v_max3_u32 v1, v72, v73, v74
    v_max3_u32 v1, v1, v75, v76
    v_max3_u32 v1, v1, v77, v78
    v_max_u32 v1, v1, v79
    v_cmp_eq_u32 vcc, -1, v1
    s_cbranch_vccz L_w2_ok
    s_sub_u32 s50, s50, 1
    s_bitcmp1_b32 s50, 31
    s_cbranch_scc1 L_w2_ok
    s_sleep 1
    s_branch L_w2
L_w2_ok:
    v_max3_f32 v72, v72, v73, v74
    v_max3_f32 v76, v76, v77, v78
    v_max3_f32 v72, v72, v75, v79
    v_max_f32 v72, v72, v76
    v_mul_f32 v73, s48, v72
    v_sub_f32 v64, v64, v73
    v_sub_f32 v65, v65, v73
    v_sub_f32 v66, v66, v73
    v_sub_f32 v67, v67, v73
    v_sub_f32 v68, v68, v73
    v_sub_f32 v69, v69, v73
    v_sub_f32 v70, v70, v73
    v_sub_f32 v71, v71, v73
    v_exp_f32 v64, v64
    v_exp_f32 v65, v65
    v_exp_f32 v66, v66
    v_exp_f32 v67, v67
    v_exp_f32 v68, v68
    v_exp_f32 v69, v69
    v_exp_f32 v70, v70
    v_exp_f32 v71, v71
    v_cvt_pk_bf16_f32 v76, v64, v65
    v_cvt_pk_bf16_f32 v77, v66, v67
    v_cvt_pk_bf16_f32 v78, v68, v69
    v_cvt_pk_bf16_f32 v79, v70, v71
    ds_write_b128 v13, v[76:79]
    v_pk_add_f32 v[64:65], v[64:65], v[66:67]
    v_pk_add_f32 v[68:69], v[68:69], v[70:71]
    v_pk_add_f32 v[64:65], v[64:65], v[68:69]
    v_add_f32 v64, v64, v65
    v_mov_b32 v65, v64
    s_nop 1
    v_permlane16_swap_b32 v64, v65
    v_add_f32 v64, v64, v65
    v_mov_b32 v65, v64
    s_nop 1
    v_permlane32_swap_b32 v64, v65
    v_add_f32 v64, v64, v65
    ds_write_b32 v12, v64 offset:128
L_w3:
    ds_read_b128 v[84:87], v9 offset:128
    ds_read_b128 v[88:91], v9 offset:144
    s_waitcnt lgkmcnt(0)
    v_max3_u32 v1, v84, v85, v86
    v_max3_u32 v1, v1, v87, v88
    v_max3_u32 v1, v1, v89, v90
    v_max_u32 v1, v1, v91
    v_cmp_eq_u32 vcc, -1, v1
    s_cbranch_vccz L_w3_ok
    s_sub_u32 s50, s50, 1
    s_bitcmp1_b32 s50, 31
    s_cbranch_scc1 L_w3_ok
    s_sleep 1
    s_branch L_w3
L_w3_ok:
    ds_read_b128 v[16:19], v11 offset:0
    ds_read_b128 v[20:23], v11 offset:256
    ds_read_b128 v[24:27], v11 offset:512
    ds_read_b128 v[28:31], v11 offset:768
    ds_read_b128 v[32:35], v11 offset:1024
    ds_read_b128 v[36:39], v11 offset:1280
    ds_read_b128 v[40:43], v11 offset:1536
    ds_read_b128 v[44:47], v11 offset:1792
    v_pk_add_f32 v[84:85], v[84:85], v[86:87]
    v_pk_add_f32 v[88:89], v[88:89], v[90:91]
    v_pk_add_f32 v[84:85], v[84:85], v[88:89]
    v_add_f32 v73, v84, v85
    v_and_or_b32 v72, v72, s38, v6
    v_and_or_b32 v73, v73, s38, v6
    s_mov_b64 exec, 15
    s_cmp_lg_u32 s3, 0
    s_cbranch_scc0 L_sw1
    global_store_dwordx2 v103, v[72:73], s[32:33]
L_sd1:
    s_mov_b64 exec, -1
    s_mov_b32 s46, 0x000f000f
    s_mov_b32 s47, 0x000f000f
L_w4:
    ds_read_b32 v86, v15 offset:24
    s_waitcnt lgkmcnt(0)
    v_cmp_eq_u32 vcc, -1, v86
    s_cbranch_vccz L_w4_ok
    s_sub_u32 s50, s50, 1
    s_bitcmp1_b32 s50, 31
    s_cbranch_scc1 L_w4_ok
    s_sleep 1
    s_branch L_w4
L_w4_ok:
    ds_read_b64_tr_b16 v[124:125], v14 offset:0
    ds_read_b64_tr_b16 v[126:127], v14 offset:4096
    ds_read_b64_tr_b16 v[128:129], v14 offset:8192
    ds_read_b64_tr_b16 v[130:131], v14 offset:12288
    ds_read_b64_tr_b16 v[132:133], v14 offset:16384
    ds_read_b64_tr_b16 v[134:135], v14 offset:20480
    ds_read_b64_tr_b16 v[136:137], v14 offset:24576
    ds_read_b64_tr_b16 v[138:139], v14 offset:28672
    ds_read_b64_tr_b16 v[140:141], v14 offset:32768
    ds_read_b64_tr_b16 v[142:143], v14 offset:36864
    s_waitcnt lgkmcnt(8)
    v_mfma_f32_16x16x32_bf16 v[64:67], v[124:127], v[16:19], 0
    s_waitcnt lgkmcnt(6)
    v_mfma_f32_16x16x32_bf16 v[64:67], v[128:131], v[20:23], v[64:67]
    s_waitcnt lgkmcnt(4)
    v_mfma_f32_16x16x32_bf16 v[64:67], v[132:135], v[24:27], v[64:67]
    s_waitcnt lgkmcnt(2)
    v_mfma_f32_16x16x32_bf16 v[64:67], v[136:139], v[28:31], v[64:67]
    s_waitcnt lgkmcnt(0)
    v_mfma_f32_16x16x32_bf16 v[64:67], v[140:143], v[32:35], v[64:67]
    s_barrier
    ds_read_b64_tr_b16 v[144:145], v14 offset:40960
    ds_read_b64_tr_b16 v[146:147], v14 offset:45056
    ds_read_b64_tr_b16 v[148:149], v14 offset:49152
    ds_read_b64_tr_b16 v[150:151], v14 offset:53248
    ds_read_b64_tr_b16 v[152:153], v14 offset:57344
    ds_read_b64_tr_b16 v[154:155], v14 offset:61440
    global_load_dwordx2 v[84:85], v105, s[32:33] sc1
    s_waitcnt lgkmcnt(4)
    v_mfma_f32_16x16x32_bf16 v[64:67], v[144:147], v[36:39], v[64:67]
    s_waitcnt lgkmcnt(2)
    v_mfma_f32_16x16x32_bf16 v[64:67], v[148:151], v[40:43], v[64:67]
    s_waitcnt lgkmcnt(0)
    v_mfma_f32_16x16x32_bf16 v[64:67], v[152:155], v[44:47], v[64:67]
    ds_read_b128 v[96:99], v110
    ds_read_b128 v[112:115], v15
    ds_read_b32 v107, v15 offset:416
    s_mov_b64 exec, s[46:47]
    s_cmp_lg_u32 s3, 0
    s_nop 2
    v_and_or_b32 v64, v64, s38, v6
    v_and_or_b32 v65, v65, s38, v6
    v_and_or_b32 v66, v66, s38, v6
    v_and_or_b32 v67, v67, s38, v6
    s_cbranch_scc0 L_sw2
    global_store_dwordx4 v102, v[64:67], s[32:33]
L_sd2:
    s_mov_b64 exec, -1
    s_waitcnt lgkmcnt(0)
    v_add_u32 v111, v111, v107
    v_add_u32 v116, v116, v107
    s_sleep 8
    global_load_dwordx4 v[80:83], v104, s[32:33] sc1
    s_waitcnt vmcnt(2)
L_ml:
    v_xor_b32 v84, s41, v84
    v_xor_b32 v85, s41, v85
    v_or_b32 v86, v84, v85
    v_and_b32 v86, 0x3ff, v86
    v_cmp_ne_u32 vcc, 0, v86
    s_cbranch_vccz L_ml_ok
    s_sub_u32 s50, s50, 1
    s_bitcmp1_b32 s50, 31
    s_cbranch_scc1 L_ml_ok
    global_load_dwordx2 v[84:85], v105, s[32:33] sc1
    s_waitcnt vmcnt(0)
    s_branch L_ml
L_ml_ok:
    v_max_f32_dpp v86, v84, v84 row_ror:4 row_mask:0xf bank_mask:0xf
    s_nop 1
    v_max_f32_dpp v86, v86, v86 row_ror:8 row_mask:0xf bank_mask:0xf
    v_mov_b32 v87, v86
    s_nop 1
    v_permlane16_swap_b32 v86, v87
    v_max_f32 v86, v86, v87
    v_mov_b32 v87, v86
    s_nop 1
    v_permlane32_swap_b32 v86, v87
    v_max_f32 v86, v86, v87
    v_sub_f32 v84, v84, v86
    v_mul_f32 v84, s48, v84
    v_exp_f32 v84, v84
    s_nop 0
    v_mul_f32 v85, v85, v84
    v_mov_b32 v87, v85
    s_nop 1
    v_permlane32_swap_b32 v85, v87
    v_add_f32 v85, v85, v87
    v_mov_b32 v87, v85
    s_nop 1
    v_permlane16_swap_b32 v85, v87
    v_add_f32 v85, v85, v87
    s_nop 1
    v_add_f32_dpp v85, v85, v85 row_ror:4 row_mask:0xf bank_mask:0xf
    s_nop 1
    v_add_f32_dpp v85, v85, v85 row_ror:8 row_mask:0xf bank_mask:0xf
    v_rcp_f32 v85, v85
    s_waitcnt vmcnt(0)
L_a:
    v_xor_b32 v80, s41, v80
    v_xor_b32 v81, s41, v81
    v_xor_b32 v82, s41, v82
    v_xor_b32 v83, s41, v83
    v_or3_b32 v86, v80, v81, v82
    v_or_b32 v86, v86, v83
    v_and_b32 v86, 0x3ff, v86
    v_cmp_ne_u32 vcc, 0, v86
    s_cbranch_vccz L_a_ok
    s_sub_u32 s50, s50, 1
    s_bitcmp1_b32 s50, 31
    s_cbranch_scc1 L_a_ok
    s_mov_b64 exec, vcc
    global_load_dwordx4 v[80:83], v104, s[32:33] sc1
    s_waitcnt vmcnt(0)
    s_branch L_a
L_a_ok:
    s_mov_b64 exec, -1
    v_pk_mul_f32 v[76:77], v[80:81], v[84:85] op_sel_hi:[1,0]
    v_pk_mul_f32 v[78:79], v[82:83], v[84:85] op_sel_hi:[1,0]
    s_nop 1
    v_permlane32_swap_b32 v76, v78
    v_permlane32_swap_b32 v77, v79
    v_add_f32 v76, v76, v78
    v_add_f32 v77, v77, v79
    s_nop 1
    v_permlane16_swap_b32 v76, v77
    v_add_f32 v76, v76, v77
    s_nop 1
    v_add_f32_dpp v76, v76, v76 row_ror:4 row_mask:0xf bank_mask:0xf
    s_nop 1
    v_add_f32_dpp v76, v76, v76 row_ror:8 row_mask:0xf bank_mask:0xf
    s_cmp_lg_u32 s35, 0
    v_mul_f32 v76, v76, v85
    v_cvt_pk_bf16_f32 v76, v76, v76
    ds_write_b16 v108, v76
    s_cbranch_scc1 L_noe
    global_load_dwordx4 v[124:127], v116, s[32:33] sc1
L_noe:
    s_waitcnt lgkmcnt(0)
    s_barrier
    ds_read_b64_tr_b16 v[92:93], v5 offset:16384
    ds_read_b64_tr_b16 v[94:95], v5 offset:20480
    ds_read_b128 v[24:27], v109
    ds_read_b64_tr_b16 v[16:17], v5
    ds_read_b64_tr_b16 v[18:19], v5 offset:4096
    ds_read_b128 v[28:31], v109 offset:64
    ds_read_b64_tr_b16 v[20:21], v5 offset:8192
    ds_read_b64_tr_b16 v[22:23], v5 offset:12288
    s_waitcnt lgkmcnt(6)
    v_mfma_f32_16x16x32_bf16 v[76:79], v[96:99], v[92:95], 0
    s_waitcnt lgkmcnt(3)
    v_mfma_f32_16x16x32_bf16 v[72:75], v[24:27], v[16:19], 0
    s_waitcnt lgkmcnt(0)
    v_mfma_f32_16x16x32_bf16 v[72:75], v[28:31], v[20:23], v[72:75]
    s_mov_b64 exec, 0xffff
    s_cmp_lg_u32 s53, 0
    s_nop 4
    v_pk_mul_f32 v[76:77], v[76:77], v[114:115]
    v_pk_fma_f32 v[76:77], v[72:73], v[112:113], v[76:77]
    v_and_or_b32 v76, v76, s38, v6
    v_and_or_b32 v77, v77, s38, v100
    s_cbranch_scc1 L_ofast
    global_store_dwordx2 v111, v[76:77], s[32:33] sc1
L_odone:
    s_cmp_lg_u32 s35, 0
    s_cbranch_scc1 L_fin
    s_mov_b64 exec, -1
    s_waitcnt vmcnt(1)
L_o1:
    v_xor_b32 v88, s41, v124
    v_xor_b32 v89, s40, v125
    v_xor_b32 v90, s41, v126
    v_xor_b32 v91, s40, v127
    v_or3_b32 v86, v88, v89, v90
    v_or_b32 v86, v86, v91
    v_and_b32 v86, 0x3ff, v86
    v_cmp_ne_u32 vcc, 0, v86
    s_cbranch_vccz L_o_ok
    s_cmp_eq_u32 s56, 0
    s_cbranch_scc1 L_op
    s_sub_u32 s50, s50, 1
    s_bitcmp1_b32 s50, 31
    s_cbranch_scc1 L_o_ok
    global_load_dwordx4 v[124:127], v116, s[32:33] sc1
    s_waitcnt vmcnt(0)
    s_branch L_o1
L_op:
    global_load_dwordx4 v[124:127], v116, s[32:33] sc1
    s_sleep 2
    global_load_dwordx4 v[128:131], v116, s[32:33] sc1
    s_sleep 2
L_o2:
    global_load_dwordx4 v[132:135], v116, s[32:33] sc1
    s_sleep 1
    s_waitcnt vmcnt(2)
    v_xor_b32 v88, s41, v124
    v_xor_b32 v89, s40, v125
    v_xor_b32 v90, s41, v126
    v_xor_b32 v91, s40, v127
    v_or3_b32 v86, v88, v89, v90
    v_or_b32 v86, v86, v91
    v_and_b32 v86, 0x3ff, v86
    v_cmp_ne_u32 vcc, 0, v86
    s_cbranch_vccz L_o_ok
    global_load_dwordx4 v[124:127], v116, s[32:33] sc1
    s_sleep 1
    s_waitcnt vmcnt(2)
    v_xor_b32 v88, s41, v128
    v_xor_b32 v89, s40, v129
    v_xor_b32 v90, s41, v130
    v_xor_b32 v91, s40, v131
    v_or3_b32 v86, v88, v89, v90
    v_or_b32 v86, v86, v91
    v_and_b32 v86, 0x3ff, v86
    v_cmp_ne_u32 vcc, 0, v86
    s_cbranch_vccz L_o_ok
    global_load_dwordx4 v[128:131], v116, s[32:33] sc1
    s_sleep 1
    s_waitcnt vmcnt(2)
    v_xor_b32 v88, s41, v132
    v_xor_b32 v89, s40, v133
    v_xor_b32 v90, s41, v134
    v_xor_b32 v91, s40, v135
    v_or3_b32 v86, v88, v89, v90
    v_or_b32 v86, v86, v91
    v_and_b32 v86, 0x3ff, v86
    v_cmp_ne_u32 vcc, 0, v86
    s_cbranch_vccz L_o_ok
    s_sub_u32 s50, s50, 1
    s_bitcmp1_b32 s50, 31
    s_cbranch_scc0 L_o2
L_o_ok:
    v_permlane32_swap_b32 v88, v90
    v_permlane32_swap_b32 v89, v91
    v_add_f32 v88, v88, v90
    v_add_f32 v89, v89, v91
    s_nop 1
    v_permlane16_swap_b32 v88, v89
    v_add_f32 v88, v88, v89
    s_nop 1
    v_add_f32_dpp v88, v88, v88 row_ror:8 row_mask:0xf bank_mask:0xf
    ds_write_b32 v117, v88
    s_mov_b64 exec, 1
    ds_inc_rtn_u32 v89, v15, v5 offset:28
    s_mov_b32 exec_lo, -1
    ds_read_b128 v[80:83], v118
    ds_read_b128 v[84:87], v118 offset:16
    s_waitcnt lgkmcnt(0)
    v_readfirstlane_b32 s45, v89
    v_pk_add_f32 v[80:81], v[80:81], v[82:83]
    v_pk_add_f32 v[84:85], v[84:85], v[86:87]
    v_pk_add_f32 v[80:81], v[80:81], v[84:85]
    s_cmp_lg_u32 s45, 6
    v_add_f32 v80, v80, v81
    s_cbranch_scc1 L_fin
    v_cvt_pk_bf16_f32 v80, v80, v80
    global_store_short v119, v80, s[28:29]
    s_cmp_lg_u32 s2, 0
    s_cbranch_scc1 L_fin
    s_mov_b64 exec, 1
    v_mov_b32 v13, 0
    v_mov_b32 v14, s34
    global_store_dword v13, v14, s[32:33]
L_fin:
    s_endpgm
L_sw1:
    global_store_dwordx2 v103, v[72:73], s[32:33] sc1
    s_branch L_sd1
L_sw2:
    global_store_dwordx4 v102, v[64:67], s[32:33] sc1
    s_branch L_sd2
L_ofast:
    global_store_dwordx2 v111, v[76:77], s[32:33]
    s_branch L_odone
L_q2:
    s_load_dword s34, s[32:33], 0
    s_mov_b32 s38, 0xfffffc00
    s_mov_b32 s50, 1000000
    s_mov_b32 s39, 0x05040100
    s_mov_b32 s40, 0x07060302
    s_mov_b32 s42, 0x11111111
    s_mov_b32 s43, 0x11111111
    s_lshl_b32 s46, s35, 14
    s_add_u32 s46, s46, 4096
    s_lshl_b32 s47, s45, 10
    s_add_u32 s47, s47, s44
    s_lshl_b32 s47, s47, 1
    s_add_u32 s47, s47, s46
    v_and_b32 v5, 1, v2
    v_lshlrev_b32 v5, 13, v5
    v_lshl_add_u32 v5, v3, 4, v5
    v_lshrrev_b32 v6, 1, v2
    v_lshl_add_u32 v5, v6, 7, v5
    v_add_u32 v5, s47, v5
    s_lshr_b32 s47, s36, 4
    s_lshl_b32 s47, s47, 13
    s_add_u32 s47, s47, s46
    v_lshl_add_u32 v6, v0, 4, s47
    v_add_u32 v4, 0x1000, v6
    s_getreg_b32 s51, hwreg(HW_REG_XCC_ID, 0, 3)
    s_waitcnt vmcnt(16)
    v_cndmask_b32 v80, 0, v8, s[42:43]
    v_cndmask_b32 v81, 0, v9, s[42:43]
    v_cndmask_b32 v82, 0, v10, s[42:43]
    v_cndmask_b32 v83, 0, v11, s[42:43]
    v_cndmask_b32 v96, 0, v12, s[42:43]
    v_cndmask_b32 v97, 0, v13, s[42:43]
    v_cndmask_b32 v98, 0, v14, s[42:43]
    v_cndmask_b32 v99, 0, v15, s[42:43]
    s_lshl_b64 s[42:43], s[42:43], 1
    v_cndmask_b32 v84, 0, v8, s[42:43]
    v_cndmask_b32 v85, 0, v9, s[42:43]
    v_cndmask_b32 v86, 0, v10, s[42:43]
    v_cndmask_b32 v87, 0, v11, s[42:43]
    v_cndmask_b32 v100, 0, v12, s[42:43]
    v_cndmask_b32 v101, 0, v13, s[42:43]
    v_cndmask_b32 v102, 0, v14, s[42:43]
    v_cndmask_b32 v103, 0, v15, s[42:43]
    s_lshl_b64 s[42:43], s[42:43], 1
    v_cndmask_b32 v88, 0, v8, s[42:43]
    v_cndmask_b32 v89, 0, v9, s[42:43]
    v_cndmask_b32 v90, 0, v10, s[42:43]
    v_cndmask_b32 v91, 0, v11, s[42:43]
    v_cndmask_b32 v104, 0, v12, s[42:43]
    v_cndmask_b32 v105, 0, v13, s[42:43]
    v_cndmask_b32 v106, 0, v14, s[42:43]
    v_cndmask_b32 v107, 0, v15, s[42:43]
    s_lshl_b64 s[42:43], s[42:43], 1
    v_cndmask_b32 v92, 0, v8, s[42:43]
    v_cndmask_b32 v93, 0, v9, s[42:43]
    v_cndmask_b32 v94, 0, v10, s[42:43]
    v_cndmask_b32 v95, 0, v11, s[42:43]
    v_cndmask_b32 v108, 0, v12, s[42:43]
    v_cndmask_b32 v109, 0, v13, s[42:43]
    v_cndmask_b32 v110, 0, v14, s[42:43]
    v_cndmask_b32 v111, 0, v15, s[42:43]
    s_waitcnt vmcnt(14)
    v_perm_b32 v112, v20, v16, s39
    v_perm_b32 v116, v20, v16, s40
    v_perm_b32 v120, v21, v17, s39
    v_perm_b32 v124, v21, v17, s40
    v_perm_b32 v128, v22, v18, s39
    v_perm_b32 v132, v22, v18, s40
    v_perm_b32 v136, v23, v19, s39
    v_perm_b32 v140, v23, v19, s40
    s_waitcnt vmcnt(12)
    v_perm_b32 v113, v28, v24, s39
    v_perm_b32 v117, v28, v24, s40
    v_perm_b32 v121, v29, v25, s39
    v_perm_b32 v125, v29, v25, s40
    v_perm_b32 v129, v30, v26, s39
    v_perm_b32 v133, v30, v26, s40
    v_perm_b32 v137, v31, v27, s39
    v_perm_b32 v141, v31, v27, s40
    s_waitcnt vmcnt(10)
    v_perm_b32 v114, v36, v32, s39
    v_perm_b32 v118, v36, v32, s40
    v_perm_b32 v122, v37, v33, s39
    v_perm_b32 v126, v37, v33, s40
    v_perm_b32 v130, v38, v34, s39
    v_perm_b32 v134, v38, v34, s40
    v_perm_b32 v138, v39, v35, s39
    v_perm_b32 v142, v39, v35, s40
    s_waitcnt vmcnt(8)
    v_perm_b32 v115, v44, v40, s39
    v_perm_b32 v119, v44, v40, s40
    v_perm_b32 v123, v45, v41, s39
    v_perm_b32 v127, v45, v41, s40
    v_perm_b32 v131, v46, v42, s39
    v_perm_b32 v135, v46, v42, s40
    v_perm_b32 v139, v47, v43, s39
    v_perm_b32 v143, v47, v43, s40
    v_mfma_f32_16x16x32_bf16 v[144:147], v[80:83], v[112:115], 0
    v_mfma_f32_16x16x32_bf16 v[144:147], v[84:87], v[116:119], v[144:147]
    v_mfma_f32_16x16x32_bf16 v[144:147], v[88:91], v[120:123], v[144:147]
    v_mfma_f32_16x16x32_bf16 v[144:147], v[92:95], v[124:127], v[144:147]
    v_mfma_f32_16x16x32_bf16 v[148:151], v[80:83], v[128:131], 0
    v_mfma_f32_16x16x32_bf16 v[148:151], v[84:87], v[132:135], v[148:151]
    v_mfma_f32_16x16x32_bf16 v[148:151], v[88:91], v[136:139], v[148:151]
    v_mfma_f32_16x16x32_bf16 v[148:151], v[92:95], v[140:143], v[148:151]
    s_waitcnt lgkmcnt(0)
    s_add_u32 s34, s34, 1
    s_and_b32 s41, s34, 0x3ff
    s_and_b32 s52, s34, 7
    s_bfe_u32 s53, s34, 0x30003
    s_bfe_u32 s54, s34, 0x30006
    v_mov_b32 v8, s52
    v_mov_b32 v9, s53
    v_mov_b32 v10, s54
    v_mov_b32 v11, s51
    s_waitcnt vmcnt(6)
    v_perm_b32 v112, v52, v48, s39
    v_perm_b32 v116, v52, v48, s40
    v_perm_b32 v120, v53, v49, s39
    v_perm_b32 v124, v53, v49, s40
    v_perm_b32 v128, v54, v50, s39
    v_perm_b32 v132, v54, v50, s40
    v_perm_b32 v136, v55, v51, s39
    v_perm_b32 v140, v55, v51, s40
    s_waitcnt vmcnt(4)
    v_perm_b32 v113, v60, v56, s39
    v_perm_b32 v117, v60, v56, s40
    v_perm_b32 v121, v61, v57, s39
    v_perm_b32 v125, v61, v57, s40
    v_perm_b32 v129, v62, v58, s39
    v_perm_b32 v133, v62, v58, s40
    v_perm_b32 v137, v63, v59, s39
    v_perm_b32 v141, v63, v59, s40
    s_waitcnt vmcnt(2)
    v_perm_b32 v114, v68, v64, s39
    v_perm_b32 v118, v68, v64, s40
    v_perm_b32 v122, v69, v65, s39
    v_perm_b32 v126, v69, v65, s40
    v_perm_b32 v130, v70, v66, s39
    v_perm_b32 v134, v70, v66, s40
    v_perm_b32 v138, v71, v67, s39
    v_perm_b32 v142, v71, v67, s40
    s_waitcnt vmcnt(0)
    v_perm_b32 v115, v76, v72, s39
    v_perm_b32 v119, v76, v72, s40
    v_perm_b32 v123, v77, v73, s39
    v_perm_b32 v127, v77, v73, s40
    v_perm_b32 v131, v78, v74, s39
    v_perm_b32 v135, v78, v74, s40
    v_perm_b32 v139, v79, v75, s39
    v_perm_b32 v143, v79, v75, s40
    v_mfma_f32_16x16x32_bf16 v[144:147], v[96:99], v[112:115], v[144:147]
    v_mfma_f32_16x16x32_bf16 v[144:147], v[100:103], v[116:119], v[144:147]
    v_mfma_f32_16x16x32_bf16 v[144:147], v[104:107], v[120:123], v[144:147]
    v_mfma_f32_16x16x32_bf16 v[144:147], v[108:111], v[124:127], v[144:147]
    v_mfma_f32_16x16x32_bf16 v[148:151], v[96:99], v[128:131], v[148:151]
    v_mfma_f32_16x16x32_bf16 v[148:151], v[100:103], v[132:135], v[148:151]
    v_mfma_f32_16x16x32_bf16 v[148:151], v[104:107], v[136:139], v[148:151]
    v_mfma_f32_16x16x32_bf16 v[148:151], v[108:111], v[140:143], v[148:151]
    s_nop 7
    v_permlane32_swap_b32 v144, v148
    v_permlane32_swap_b32 v145, v149
    v_permlane32_swap_b32 v146, v150
    v_permlane32_swap_b32 v147, v151
    v_add_f32_dpp v144, v148, v144 row_ror:8 row_mask:0xf bank_mask:0xf
    v_add_f32_dpp v145, v149, v145 row_ror:8 row_mask:0xf bank_mask:0xf
    v_add_f32_dpp v146, v150, v146 row_ror:8 row_mask:0xf bank_mask:0xf
    v_add_f32_dpp v147, v151, v147 row_ror:8 row_mask:0xf bank_mask:0xf
    s_mov_b32 exec_lo, 0x00ff00ff
    s_mov_b32 exec_hi, 0x00ff00ff
    v_and_or_b32 v144, v144, -8, v8
    v_and_or_b32 v145, v145, -8, v9
    v_and_or_b32 v146, v146, -8, v10
    v_and_or_b32 v147, v147, -8, v11
    global_store_dwordx4 v5, v[144:147], s[32:33]
    s_mov_b64 exec, -1
    s_waitcnt vmcnt(0)
L_qg:
    global_load_dwordx4 v[16:19], v6, s[32:33] offset:0 sc1
    global_load_dwordx4 v[20:23], v6, s[32:33] offset:1024 sc1
    global_load_dwordx4 v[24:27], v6, s[32:33] offset:2048 sc1
    global_load_dwordx4 v[28:31], v6, s[32:33] offset:3072 sc1
    global_load_dwordx4 v[32:35], v4, s[32:33] offset:0 sc1
    global_load_dwordx4 v[36:39], v4, s[32:33] offset:1024 sc1
    global_load_dwordx4 v[40:43], v4, s[32:33] offset:2048 sc1
    global_load_dwordx4 v[44:47], v4, s[32:33] offset:3072 sc1
    s_waitcnt vmcnt(7)
    v_xor_b32 v12, v8, v16
    v_and_b32 v16, -8, v16
    v_bitop3_b32 v12, v12, v17, v9 bitop3:0xf6
    v_and_b32 v17, -8, v17
    v_bitop3_b32 v12, v12, v18, v10 bitop3:0xf6
    v_and_b32 v18, -8, v18
    v_xor_b32 v13, v11, v19
    v_and_b32 v19, -8, v19
    s_waitcnt vmcnt(6)
    v_bitop3_b32 v12, v12, v20, v8 bitop3:0xf6
    v_and_b32 v20, -8, v20
    v_bitop3_b32 v12, v12, v21, v9 bitop3:0xf6
    v_and_b32 v21, -8, v21
    v_bitop3_b32 v12, v12, v22, v10 bitop3:0xf6
    v_and_b32 v22, -8, v22
    v_bitop3_b32 v13, v13, v23, v11 bitop3:0xf6
    v_and_b32 v23, -8, v23
    s_waitcnt vmcnt(5)
    v_bitop3_b32 v12, v12, v24, v8 bitop3:0xf6
    v_and_b32 v24, -8, v24
    v_bitop3_b32 v12, v12, v25, v9 bitop3:0xf6
    v_and_b32 v25, -8, v25
    v_bitop3_b32 v12, v12, v26, v10 bitop3:0xf6
    v_and_b32 v26, -8, v26
    v_bitop3_b32 v13, v13, v27, v11 bitop3:0xf6
    v_and_b32 v27, -8, v27
    v_pk_add_f32 v[16:17], v[16:17], v[24:25]
    v_pk_add_f32 v[18:19], v[18:19], v[26:27]
    s_waitcnt vmcnt(4)
    v_bitop3_b32 v12, v12, v28, v8 bitop3:0xf6
    v_and_b32 v28, -8, v28
    v_bitop3_b32 v12, v12, v29, v9 bitop3:0xf6
    v_and_b32 v29, -8, v29
    v_bitop3_b32 v12, v12, v30, v10 bitop3:0xf6
    v_and_b32 v30, -8, v30
    v_bitop3_b32 v13, v13, v31, v11 bitop3:0xf6
    v_and_b32 v31, -8, v31
    v_pk_add_f32 v[20:21], v[20:21], v[28:29]
    v_pk_add_f32 v[22:23], v[22:23], v[30:31]
    s_waitcnt vmcnt(3)
    v_bitop3_b32 v12, v12, v32, v8 bitop3:0xf6
    v_and_b32 v32, -8, v32
    v_bitop3_b32 v12, v12, v33, v9 bitop3:0xf6
    v_and_b32 v33, -8, v33
    v_bitop3_b32 v12, v12, v34, v10 bitop3:0xf6
    v_and_b32 v34, -8, v34
    v_bitop3_b32 v13, v13, v35, v11 bitop3:0xf6
    v_and_b32 v35, -8, v35
    v_pk_add_f32 v[16:17], v[16:17], v[32:33]
    v_pk_add_f32 v[18:19], v[18:19], v[34:35]
    s_waitcnt vmcnt(2)
    v_bitop3_b32 v12, v12, v36, v8 bitop3:0xf6
    v_and_b32 v36, -8, v36
    v_bitop3_b32 v12, v12, v37, v9 bitop3:0xf6
    v_and_b32 v37, -8, v37
    v_bitop3_b32 v12, v12, v38, v10 bitop3:0xf6
    v_and_b32 v38, -8, v38
    v_bitop3_b32 v13, v13, v39, v11 bitop3:0xf6
    v_and_b32 v39, -8, v39
    v_pk_add_f32 v[20:21], v[20:21], v[36:37]
    v_pk_add_f32 v[22:23], v[22:23], v[38:39]
    s_waitcnt vmcnt(1)
    v_bitop3_b32 v12, v12, v40, v8 bitop3:0xf6
    v_and_b32 v40, -8, v40
    v_bitop3_b32 v12, v12, v41, v9 bitop3:0xf6
    v_and_b32 v41, -8, v41
    v_bitop3_b32 v12, v12, v42, v10 bitop3:0xf6
    v_and_b32 v42, -8, v42
    v_bitop3_b32 v13, v13, v43, v11 bitop3:0xf6
    v_and_b32 v43, -8, v43
    v_pk_add_f32 v[16:17], v[16:17], v[40:41]
    v_pk_add_f32 v[18:19], v[18:19], v[42:43]
    s_waitcnt vmcnt(0)
    v_bitop3_b32 v12, v12, v44, v8 bitop3:0xf6
    v_and_b32 v44, -8, v44
    v_bitop3_b32 v12, v12, v45, v9 bitop3:0xf6
    v_and_b32 v45, -8, v45
    v_bitop3_b32 v12, v12, v46, v10 bitop3:0xf6
    v_and_b32 v46, -8, v46
    v_bitop3_b32 v13, v13, v47, v11 bitop3:0xf6
    v_and_b32 v47, -8, v47
    v_pk_add_f32 v[20:21], v[20:21], v[44:45]
    v_pk_add_f32 v[22:23], v[22:23], v[46:47]
    v_and_b32 v12, 7, v12
    v_cmp_ne_u32 vcc, 0, v12
    s_cbranch_vccz L_qdone
    s_sub_u32 s50, s50, 1
    s_bitcmp1_b32 s50, 31
    s_cbranch_scc1 L_qdone
    s_cmp_lg_u32 s50, 999998
    s_cbranch_scc1 L_qg
    s_mov_b32 exec_lo, 0x00ff00ff
    s_mov_b32 exec_hi, 0x00ff00ff
    global_store_dwordx4 v5, v[144:147], s[32:33] sc1
    s_mov_b64 exec, -1
    s_branch L_qg
L_qdone:
    v_and_b32 v13, 7, v13
    v_cmp_ne_u32 vcc, 0, v13
    s_cbranch_vccz L_qloc
    s_mov_b32 exec_lo, 0x00ff00ff
    s_mov_b32 exec_hi, 0x00ff00ff
    global_store_dwordx4 v5, v[144:147], s[32:33] sc1
    s_mov_b64 exec, -1
L_qloc:
    v_cvt_pk_bf16_f32 v12, v16, v17
    v_cvt_pk_bf16_f32 v13, v18, v19
    v_cvt_pk_bf16_f32 v14, v20, v21
    v_cvt_pk_bf16_f32 v15, v22, v23
    v_and_b32 v4, 7, v0
    v_lshlrev_b32 v4, 4, v4
    v_lshl_add_u32 v4, v2, 7, v4
    v_and_b32 v5, 8, v0
    v_add_u32 v4, v4, v5
    v_add_u32 v4, 155648, v4
    ds_write_b64 v4, v[12:13] offset:0
    ds_write_b64 v4, v[14:15] offset:512
    s_cmp_eq_u64 vcc, 0
    s_cselect_b32 s44, 1, 0
    v_mov_b32 v4, 158992
    v_mov_b32 v5, s44
    ds_write_b32 v4, v5
    s_waitcnt lgkmcnt(0)
    s_endpgm
L_f2:
    s_load_dword s34, s[32:33], 0
    s_mov_b32 s38, 0xfffffc00
    s_mov_b32 s50, 1000000
    s_mov_b32 s49, 0xffff0000
    s_cmp_lt_u32 s36, s54
    s_cbranch_scc1 L_fmain
    s_waitcnt lgkmcnt(0)
    s_add_u32 s34, s34, 1
    s_and_b32 s41, s34, 0x3ff
    s_waitcnt vmcnt(0)
    s_branch L_fgate
L_fmain:
    s_mov_b32 s39, 0x05040100
    s_mov_b32 s40, 0x07060302
    s_mov_b32 s42, 0x03030303
    s_mov_b32 s43, 0x03030303
    s_lshl_b32 s46, s45, 13
    s_lshl_b32 s47, s44, 10
    s_add_u32 s46, s46, s47
    s_add_u32 s46, s46, 135168
    v_add_u32 v5, s46, v6
    s_waitcnt vmcnt(19)
    v_cndmask_b32 v80, 0, v8, s[42:43]
    v_cndmask_b32 v81, 0, v9, s[42:43]
    v_cndmask_b32 v82, 0, v10, s[42:43]
    v_cndmask_b32 v83, 0, v11, s[42:43]
    s_lshl_b64 s[42:43], s[42:43], 2
    v_cndmask_b32 v84, 0, v8, s[42:43]
    v_cndmask_b32 v85, 0, v9, s[42:43]
    v_cndmask_b32 v86, 0, v10, s[42:43]
    v_cndmask_b32 v87, 0, v11, s[42:43]
    s_lshl_b64 s[42:43], s[42:43], 2
    v_cndmask_b32 v88, 0, v8, s[42:43]
    v_cndmask_b32 v89, 0, v9, s[42:43]
    v_cndmask_b32 v90, 0, v10, s[42:43]
    v_cndmask_b32 v91, 0, v11, s[42:43]
    s_lshl_b64 s[42:43], s[42:43], 2
    v_cndmask_b32 v92, 0, v8, s[42:43]
    v_cndmask_b32 v93, 0, v9, s[42:43]
    v_cndmask_b32 v94, 0, v10, s[42:43]
    v_cndmask_b32 v95, 0, v11, s[42:43]
    s_waitcnt lgkmcnt(0)
    s_add_u32 s34, s34, 1
    s_and_b32 s41, s34, 0x3ff
    v_mov_b32 v7, s41
    s_waitcnt vmcnt(3)
    v_perm_b32 v112, v20, v16, s39
    v_perm_b32 v116, v20, v16, s40
    v_perm_b32 v120, v21, v17, s39
    v_perm_b32 v124, v21, v17, s40
    v_perm_b32 v128, v22, v18, s39
    v_perm_b32 v132, v22, v18, s40
    v_perm_b32 v136, v23, v19, s39
    v_perm_b32 v140, v23, v19, s40
    v_perm_b32 v113, v28, v24, s39
    v_perm_b32 v117, v28, v24, s40
    v_perm_b32 v121, v29, v25, s39
    v_perm_b32 v125, v29, v25, s40
    v_perm_b32 v129, v30, v26, s39
    v_perm_b32 v133, v30, v26, s40
    v_perm_b32 v137, v31, v27, s39
    v_perm_b32 v141, v31, v27, s40
    v_perm_b32 v114, v36, v32, s39
    v_perm_b32 v118, v36, v32, s40
    v_perm_b32 v122, v37, v33, s39
    v_perm_b32 v126, v37, v33, s40
    v_perm_b32 v130, v38, v34, s39
    v_perm_b32 v134, v38, v34, s40
    v_perm_b32 v138, v39, v35, s39
    v_perm_b32 v142, v39, v35, s40
    v_perm_b32 v115, v44, v40, s39
    v_perm_b32 v119, v44, v40, s40
    v_perm_b32 v123, v45, v41, s39
    v_perm_b32 v127, v45, v41, s40
    v_perm_b32 v131, v46, v42, s39
    v_perm_b32 v135, v46, v42, s40
    v_perm_b32 v139, v47, v43, s39
    v_perm_b32 v143, v47, v43, s40
    v_mfma_f32_16x16x32_bf16 v[144:147], v[80:83], v[112:115], 0
    v_mfma_f32_16x16x32_bf16 v[144:147], v[88:91], v[116:119], v[144:147]
    v_mfma_f32_16x16x32_bf16 v[148:151], v[80:83], v[120:123], 0
    v_mfma_f32_16x16x32_bf16 v[148:151], v[88:91], v[124:127], v[148:151]
    v_mfma_f32_16x16x32_bf16 v[152:155], v[80:83], v[128:131], 0
    v_mfma_f32_16x16x32_bf16 v[152:155], v[88:91], v[132:135], v[152:155]
    v_mfma_f32_16x16x32_bf16 v[156:159], v[80:83], v[136:139], 0
    v_mfma_f32_16x16x32_bf16 v[156:159], v[88:91], v[140:143], v[156:159]
    v_perm_b32 v112, v52, v48, s39
    v_perm_b32 v116, v52, v48, s40
    v_perm_b32 v120, v53, v49, s39
    v_perm_b32 v124, v53, v49, s40
    v_perm_b32 v128, v54, v50, s39
    v_perm_b32 v132, v54, v50, s40
    v_perm_b32 v136, v55, v51, s39
    v_perm_b32 v140, v55, v51, s40
    v_perm_b32 v113, v60, v56, s39
    v_perm_b32 v117, v60, v56, s40
    v_perm_b32 v121, v61, v57, s39
    v_perm_b32 v125, v61, v57, s40
    v_perm_b32 v129, v62, v58, s39
    v_perm_b32 v133, v62, v58, s40
    v_perm_b32 v137, v63, v59, s39
    v_perm_b32 v141, v63, v59, s40
    v_perm_b32 v114, v68, v64, s39
    v_perm_b32 v118, v68, v64, s40
    v_perm_b32 v122, v69, v65, s39
    v_perm_b32 v126, v69, v65, s40
    v_perm_b32 v130, v70, v66, s39
    v_perm_b32 v134, v70, v66, s40
    v_perm_b32 v138, v71, v67, s39
    v_perm_b32 v142, v71, v67, s40
    v_perm_b32 v115, v76, v72, s39
    v_perm_b32 v119, v76, v72, s40
    v_perm_b32 v123, v77, v73, s39
    v_perm_b32 v127, v77, v73, s40
    v_perm_b32 v131, v78, v74, s39
    v_perm_b32 v135, v78, v74, s40
    v_perm_b32 v139, v79, v75, s39
    v_perm_b32 v143, v79, v75, s40
    v_mfma_f32_16x16x32_bf16 v[144:147], v[84:87], v[112:115], v[144:147]
    v_mfma_f32_16x16x32_bf16 v[144:147], v[92:95], v[116:119], v[144:147]
    v_mfma_f32_16x16x32_bf16 v[148:151], v[84:87], v[120:123], v[148:151]
    v_mfma_f32_16x16x32_bf16 v[148:151], v[92:95], v[124:127], v[148:151]
    v_mfma_f32_16x16x32_bf16 v[152:155], v[84:87], v[128:131], v[152:155]
    v_mfma_f32_16x16x32_bf16 v[152:155], v[92:95], v[132:135], v[152:155]
    v_mfma_f32_16x16x32_bf16 v[156:159], v[84:87], v[136:139], v[156:159]
    v_mfma_f32_16x16x32_bf16 v[156:159], v[92:95], v[140:143], v[156:159]
    s_nop 3
    v_permlane32_swap_b32 v144, v148
    v_permlane32_swap_b32 v145, v149
    v_permlane32_swap_b32 v146, v150
    v_permlane32_swap_b32 v147, v151
    v_permlane32_swap_b32 v152, v156
    v_permlane32_swap_b32 v153, v157
    v_permlane32_swap_b32 v154, v158
    v_permlane32_swap_b32 v155, v159
    v_add_f32_dpp v144, v148, v144 row_ror:8 row_mask:0xf bank_mask:0x3
    v_add_f32_dpp v145, v149, v145 row_ror:8 row_mask:0xf bank_mask:0x3
    v_add_f32_dpp v146, v150, v146 row_ror:8 row_mask:0xf bank_mask:0x3
    v_add_f32_dpp v147, v151, v147 row_ror:8 row_mask:0xf bank_mask:0x3
    v_add_f32_dpp v144, v152, v156 row_ror:8 row_mask:0xf bank_mask:0xc
    v_add_f32_dpp v145, v153, v157 row_ror:8 row_mask:0xf bank_mask:0xc
    v_add_f32_dpp v146, v154, v158 row_ror:8 row_mask:0xf bank_mask:0xc
    v_add_f32_dpp v147, v155, v159 row_ror:8 row_mask:0xf bank_mask:0xc
    v_and_or_b32 v144, v144, s38, v7
    v_and_or_b32 v145, v145, s38, v7
    v_and_or_b32 v146, v146, s38, v7
    v_and_or_b32 v147, v147, s38, v7
    global_store_dwordx4 v5, v[144:147], s[32:33]
L_fgate:
    s_waitcnt vmcnt(1)
    v_and_b32 v93, s49, v104
    v_lshlrev_b32 v92, 16, v104
    v_and_b32 v95, s49, v96
    v_lshlrev_b32 v94, 16, v96
    v_pk_mul_f32 v[94:95], v[94:95], v[92:93]
    v_cvt_pk_bf16_f32 v94, v94, v95
    v_and_b32 v95, s49, v94
    v_lshlrev_b32 v94, 16, v94
    v_add_f32 v88, v94, v95
    v_and_b32 v95, s49, v100
    v_lshlrev_b32 v94, 16, v100
    v_pk_mul_f32 v[94:95], v[94:95], v[92:93]
    v_cvt_pk_bf16_f32 v94, v94, v95
    v_and_b32 v95, s49, v94
    v_lshlrev_b32 v94, 16, v94
    v_add_f32 v89, v94, v95
    v_and_b32 v93, s49, v105
    v_lshlrev_b32 v92, 16, v105
    v_and_b32 v95, s49, v97
    v_lshlrev_b32 v94, 16, v97
    v_pk_mul_f32 v[94:95], v[94:95], v[92:93]
    v_cvt_pk_bf16_f32 v94, v94, v95
    v_and_b32 v95, s49, v94
    v_lshlrev_b32 v94, 16, v94
    v_add_f32 v88, v88, v94
    v_add_f32 v88, v88, v95
    v_and_b32 v95, s49, v101
    v_lshlrev_b32 v94, 16, v101
    v_pk_mul_f32 v[94:95], v[94:95], v[92:93]
    v_cvt_pk_bf16_f32 v94, v94, v95
    v_and_b32 v95, s49, v94
    v_lshlrev_b32 v94, 16, v94
    v_add_f32 v89, v89, v94
    v_add_f32 v89, v89, v95
    v_and_b32 v93, s49, v106
    v_lshlrev_b32 v92, 16, v106
    v_and_b32 v95, s49, v98
    v_lshlrev_b32 v94, 16, v98
    v_pk_mul_f32 v[94:95], v[94:95], v[92:93]
    v_cvt_pk_bf16_f32 v94, v94, v95
    v_and_b32 v95, s49, v94
    v_lshlrev_b32 v94, 16, v94
    v_add_f32 v88, v88, v94
    v_add_f32 v88, v88, v95
    v_and_b32 v95, s49, v102
    v_lshlrev_b32 v94, 16, v102
    v_pk_mul_f32 v[94:95], v[94:95], v[92:93]
    v_cvt_pk_bf16_f32 v94, v94, v95
    v_and_b32 v95, s49, v94
    v_lshlrev_b32 v94, 16, v94
    v_add_f32 v89, v89, v94
    v_add_f32 v89, v89, v95
    v_and_b32 v93, s49, v107
    v_lshlrev_b32 v92, 16, v107
    v_and_b32 v95, s49, v99
    v_lshlrev_b32 v94, 16, v99
    v_pk_mul_f32 v[94:95], v[94:95], v[92:93]
    v_cvt_pk_bf16_f32 v94, v94, v95
    v_and_b32 v95, s49, v94
    v_lshlrev_b32 v94, 16, v94
    v_add_f32 v88, v88, v94
    v_add_f32 v88, v88, v95
    v_and_b32 v95, s49, v103
    v_lshlrev_b32 v94, 16, v103
    v_pk_mul_f32 v[94:95], v[94:95], v[92:93]
    v_cvt_pk_bf16_f32 v94, v94, v95
    v_and_b32 v95, s49, v94
    v_lshlrev_b32 v94, 16, v94
    v_add_f32 v89, v89, v94
    v_add_f32 v89, v89, v95
    s_nop 1
    v_add_f32_dpp v88, v88, v88 row_ror:8 row_mask:0xf bank_mask:0xf
    v_add_f32_dpp v89, v89, v89 row_ror:8 row_mask:0xf bank_mask:0xf
    s_nop 0
    v_add_f32_dpp v88, v88, v88 row_ror:4 row_mask:0xf bank_mask:0xf
    v_add_f32_dpp v89, v89, v89 row_ror:4 row_mask:0xf bank_mask:0xf
    s_nop 0
    v_add_f32_dpp v88, v88, v88 row_ror:2 row_mask:0xf bank_mask:0xf
    v_add_f32_dpp v89, v89, v89 row_ror:2 row_mask:0xf bank_mask:0xf
    s_nop 0
    v_add_f32_dpp v88, v88, v88 row_ror:1 row_mask:0xf bank_mask:0xf
    v_add_f32_dpp v89, v89, v89 row_ror:1 row_mask:0xf bank_mask:0xf
    s_nop 0
    v_add_f32_dpp v88, v88, v88 row_bcast:15 row_mask:0xa bank_mask:0xf
    v_add_f32_dpp v89, v89, v89 row_bcast:15 row_mask:0xa bank_mask:0xf
    s_nop 0
    v_add_f32_dpp v88, v88, v88 row_bcast:31 row_mask:0xc bank_mask:0xf
    v_add_f32_dpp v89, v89, v89 row_bcast:31 row_mask:0xc bank_mask:0xf
    v_cvt_pk_bf16_f32 v88, v88, v89
    v_and_b32 v89, s49, v88
    v_lshlrev_b32 v88, 16, v88
    v_mul_f32 v88, 0xbfb8aa3b, v88
    v_mul_f32 v89, 0xbfb8aa3b, v89
    v_exp_f32 v88, v88
    v_exp_f32 v89, v89
    s_nop 0
    v_add_f32 v88, 1.0, v88
    v_add_f32 v89, 1.0, v89
    v_rcp_f32 v88, v88
    v_rcp_f32 v89, v89
    s_nop 0
    v_cvt_pk_bf16_f32 v88, v88, v89
    v_and_b32 v89, s49, v88
    v_lshlrev_b32 v88, 16, v88
    v_sub_f32 v90, 1.0, v88
    v_sub_f32 v91, 1.0, v89
    v_cvt_pk_bf16_f32 v90, v90, v91
    v_and_b32 v91, s49, v90
    v_lshlrev_b32 v90, 16, v90
    v_mov_b32 v8, 158976
    s_mov_b32 exec_lo, 0
    s_mov_b32 exec_hi, 0x80000000
    ds_write_b128 v8, v[88:91]
    s_mov_b64 exec, -1
    v_lshrrev_b32 v9, 2, v3
    v_lshlrev_b32 v9, 4, v9
    v_and_b32 v8, 1, v2
    v_lshl_add_u32 v9, v8, 3, v9
    v_and_b32 v8, 3, v0
    v_lshl_add_u32 v9, v8, 1, v9
    v_add_u32 v9, 159264, v9
    s_lshr_b32 s46, s44, 1
    s_add_u32 s46, s46, s55
    s_lshl_b32 s46, s46, 13
    s_and_b32 s47, s44, 1
    s_lshl_b32 s47, s47, 9
    s_add_u32 s46, s46, s47
    s_add_u32 s46, s46, 135168
    v_and_b32 v4, 32, v0
    v_lshlrev_b32 v4, 4, v4
    v_add3_u32 v10, v4, v6, s46
    v_add_u32 v11, 0x1000, v10
    v_mov_b32 v15, 158992
    v_mov_b32 v16, 0
    s_cmp_eq_u32 s54, 0
    s_cbranch_scc1 L_fh
    s_waitcnt vmcnt(0)
    global_load_dwordx4 v[16:19], v10, s[32:33] offset:0 sc1
    global_load_dwordx4 v[20:23], v10, s[32:33] offset:2048 sc1
    global_load_dwordx4 v[24:27], v11, s[32:33] offset:0 sc1
    global_load_dwordx4 v[28:31], v11, s[32:33] offset:2048 sc1
    s_waitcnt vmcnt(0)
L_fg:
    v_xor_b32 v16, s41, v16
    v_xor_b32 v17, s41, v17
    v_xor_b32 v18, s41, v18
    v_xor_b32 v19, s41, v19
    v_xor_b32 v20, s41, v20
    v_xor_b32 v21, s41, v21
    v_xor_b32 v22, s41, v22
    v_xor_b32 v23, s41, v23
    v_xor_b32 v24, s41, v24
    v_xor_b32 v25, s41, v25
    v_xor_b32 v26, s41, v26
    v_xor_b32 v27, s41, v27
    v_xor_b32 v28, s41, v28
    v_xor_b32 v29, s41, v29
    v_xor_b32 v30, s41, v30
    v_xor_b32 v31, s41, v31
    v_or3_b32 v8, v16, v17, v18
    v_or3_b32 v8, v8, v19, v20
    v_or3_b32 v8, v8, v21, v22
    v_or3_b32 v8, v8, v23, v24
    v_or3_b32 v8, v8, v25, v26
    v_or3_b32 v8, v8, v27, v28
    v_or3_b32 v8, v8, v29, v30
    v_or_b32 v8, v8, v31
    v_and_b32 v8, 0x3ff, v8
    v_cmp_ne_u32 vcc, 0, v8
    s_cbranch_vccz L_fg_ok
    s_sub_u32 s50, s50, 1
    s_bitcmp1_b32 s50, 31
    s_cbranch_scc1 L_fg_ok
    s_mov_b64 exec, vcc
    s_cmp_lg_u32 s50, 999998
    s_cbranch_scc1 L_fr
    s_mov_b64 exec, -1
    global_store_dwordx4 v5, v[144:147], s[32:33] sc1
    s_mov_b64 exec, vcc
L_fr:
    global_load_dwordx4 v[16:19], v10, s[32:33] offset:0 sc1
    global_load_dwordx4 v[20:23], v10, s[32:33] offset:2048 sc1
    global_load_dwordx4 v[24:27], v11, s[32:33] offset:0 sc1
    global_load_dwordx4 v[28:31], v11, s[32:33] offset:2048 sc1
    s_waitcnt vmcnt(0)
    s_branch L_fg
L_fg_ok:
    s_mov_b64 exec, -1
    v_pk_add_f32 v[16:17], v[16:17], v[24:25]
    v_pk_add_f32 v[18:19], v[18:19], v[26:27]
    v_pk_add_f32 v[20:21], v[20:21], v[28:29]
    v_pk_add_f32 v[22:23], v[22:23], v[30:31]
    v_pk_add_f32 v[16:17], v[16:17], v[20:21]
    v_pk_add_f32 v[18:19], v[18:19], v[22:23]
    v_mov_b32 v20, v16
    v_mov_b32 v21, v17
    v_mov_b32 v22, v18
    v_mov_b32 v23, v19
    v_permlane32_swap_b32 v16, v20
    v_permlane32_swap_b32 v17, v21
    v_permlane32_swap_b32 v18, v22
    v_permlane32_swap_b32 v19, v23
    v_pk_add_f32 v[16:17], v[16:17], v[20:21]
    v_pk_add_f32 v[18:19], v[18:19], v[22:23]
    v_cvt_pk_bf16_f32 v16, v16, v17
    v_cvt_pk_bf16_f32 v18, v18, v19
    v_and_b32 v17, s49, v16
    v_lshlrev_b32 v16, 16, v16
    v_and_b32 v19, s49, v18
    v_lshlrev_b32 v18, 16, v18
    v_mul_f32 v20, 0xbfb8aa3b, v16
    v_mul_f32 v21, 0xbfb8aa3b, v17
    v_exp_f32 v20, v20
    v_exp_f32 v21, v21
    s_nop 0
    v_add_f32 v20, 1.0, v20
    v_add_f32 v21, 1.0, v21
    v_rcp_f32 v20, v20
    v_rcp_f32 v21, v21
    s_nop 0
    v_pk_mul_f32 v[16:17], v[16:17], v[20:21]
    v_cvt_pk_bf16_f32 v16, v16, v17
    v_and_b32 v17, s49, v16
    v_lshlrev_b32 v16, 16, v16
    v_pk_mul_f32 v[16:17], v[16:17], v[18:19]
    v_cvt_pk_bf16_f32 v16, v16, v17
L_fw:
    ds_read_b32 v24, v15
    s_waitcnt lgkmcnt(0)
    v_cmp_eq_u32 vcc, -1, v24
    s_cbranch_vccz L_fw_ok
    s_sub_u32 s50, s50, 1
    s_bitcmp1_b32 s50, 31
    s_cbranch_scc1 L_fw_ok
    s_sleep 4
    s_branch L_fw
L_fw_ok:
    v_cmp_ne_u32 vcc, 0, v24
    s_cbranch_vccnz L_fnp
    global_store_dwordx4 v5, v[144:147], s[32:33] sc1
L_fnp:
L_fh:
    ds_write_b16 v9, v16
    ds_write_b16_d16_hi v9, v16 offset:64
    s_waitcnt lgkmcnt(0)
L_end:
    s_endpgm
.section .rodata,"a"
.p2align 6
.amdhsa_kernel gated_mix__sliding_block_cached__swiglu_ffn__decode_kernel
  .amdhsa_next_free_vgpr 168
  .amdhsa_next_free_sgpr 96
  .amdhsa_accum_offset 168
  .amdhsa_group_segment_fixed_size 0
  .amdhsa_kernarg_size 104
  .amdhsa_user_sgpr_count 2
  .amdhsa_user_sgpr_kernarg_segment_ptr 1
  .amdhsa_system_sgpr_workgroup_id_x 1
  .amdhsa_float_denorm_mode_32 3
.end_amdhsa_kernel
```
